```python
import torch

def _softmax(x, axis=-1):
    return torch.softmax(x, dim=axis)
def _gelu(x):
    return torch.nn.functional.gelu(x, approximate="tanh")
def _silu(x):
    return torch.nn.functional.silu(x)
def _sigmoid(x):
    return torch.sigmoid(x)
def _layernorm(x, axis=-1, eps=1e-5):
    m = x.mean(dim=axis, keepdim=True)
    v = x.var(dim=axis, keepdim=True, unbiased=False)
    return (x - m) / torch.sqrt(v + eps)
def _scatter_add(tgt, idx, src, axis=0):
    return tgt.clone().index_add_(axis, idx, src)
def _segment_sum(src, seg, n):
    out = torch.zeros((n,) + src.shape[1:], dtype=src.dtype)
    return out.index_add_(0, seg, src)
def _pad(x, pw):
    flat = tuple(v for pair in reversed(pw) for v in pair)
    return torch.nn.functional.pad(x, flat)

kernel_name = 'interleave_layers__gqa_block_cached__dense_activation_silu__decode'

def setup_inputs():

    _w = (lambda a: (lambda t: t.to(torch.bfloat16) if t.is_floating_point() else t)(torch.as_tensor(a)))
    def _A_setup():
        B, Sq, D = 8, 1, 512
        Hq, Hkv, Sk, Dh = 32, 8, 8192, 128
        assert Hq % Hkv == 0, (Hq, Hkv)
        return {
            "x": _w((lambda *s: torch.randn(*s, dtype=torch.bfloat16) * 0.1)(B, Sq, D)),
            "k_cache": _w((lambda *s: torch.randn(*s, dtype=torch.bfloat16) * 0.8)(B, Hkv, Sk, Dh)),
            "v_cache": _w((lambda *s: torch.randn(*s, dtype=torch.bfloat16) * 3.2)(B, Hkv, Sk, Dh)),
            "wq": _w((lambda *s: torch.randn(*s, dtype=torch.bfloat16) * 0.8)(D, Hq * Dh) * (D ** -0.5)),
            "wo": _w((lambda *s: torch.randn(*s, dtype=torch.bfloat16) * 3.2)(Hq * Dh, D) * ((Hq * Dh) ** -0.5)),
        }
    _A_in = _A_setup()

    def _B_setup():
        B, S, D, F = 8, 1, 512, 1792
        return {
            "x": _w((lambda *s: torch.randn(*s, dtype=torch.bfloat16) * 0.1)(B, S, D)),
            "w1": _w((lambda *s: torch.randn(*s, dtype=torch.bfloat16) * 1.6)(D, F) * (D ** -0.5)),
            "w2": _w((lambda *s: torch.randn(*s, dtype=torch.bfloat16) * 0.4)(F, D) * (F ** -0.5)),
        }
    _B_in = _B_setup()

    return {
        "A_x": _A_in["x"],
        "A_k_cache": _A_in["k_cache"],
        "A_v_cache": _A_in["v_cache"],
        "A_wq": _A_in["wq"],
        "A_wo": _A_in["wo"],
        "B_x": _B_in["x"],
        "B_w1": _B_in["w1"],
        "B_w2": _B_in["w2"],
    }

def reference(A_x, A_k_cache, A_v_cache, A_wq, A_wo, B_x, B_w1, B_w2):
    def _A_ref(x, k_cache, v_cache, wq, wo):
        B, Sq, D = x.shape
        Hq, Dh = 32, 128
        Hkv = k_cache.shape[1]
        rep = Hq // Hkv
        q = (lambda x, *d: x.permute(*d))((x @ wq).reshape(B, Sq, Hq, Dh), 0, 2, 1, 3)
        k = (lambda x, n, axis: torch.repeat_interleave(x, n, dim=axis))(k_cache, rep, axis=1)
        v = (lambda x, n, axis: torch.repeat_interleave(x, n, dim=axis))(v_cache, rep, axis=1)
        scores = torch.einsum("bhqd,bhkd->bhqk", q, k) * (Dh ** -0.5)
        p = _softmax(scores, axis=-1)
        o = torch.einsum("bhqk,bhkd->bhqd", p, v)
        return (lambda x, *d: x.permute(*d))(o, 0, 2, 1, 3).reshape(B, Sq, Hq * Dh) @ wo

    def _B_ref(x, w1, w2):
        h = torch.einsum("bsd,df->bsf", x, w1)
        h = _silu(h)
        out = torch.einsum("bsf,fd->bsd", h, w2)
        return out

    x = A_x
    x = x + _A_ref(_layernorm(x, axis=-1), A_k_cache, A_v_cache, A_wq, A_wo)
    x = x + _B_ref(_layernorm(x, axis=-1), B_w1, B_w2)
    x = x + _A_ref(_layernorm(x, axis=-1), A_k_cache, A_v_cache, A_wq, A_wo)
    x = x + _B_ref(_layernorm(x, axis=-1), B_w1, B_w2)
    return x
```

```asm
; @launch grid=(256,1,1) block=(256,1,1) lds=163840
.amdgcn_target "amdgcn-amd-amdhsa--gfx950"
.text
.globl interleave_layers__gqa_block_cached__dense_activation_silu__decode_kernel
.p2align 8
.type interleave_layers__gqa_block_cached__dense_activation_silu__decode_kernel,@function
interleave_layers__gqa_block_cached__dense_activation_silu__decode_kernel:
    s_cmp_ge_u32 s2, 256
    s_cbranch_scc1 L_end
    s_load_dwordx2 s[76:77], s[0:1], 24
    s_load_dwordx2 s[8:9], s[0:1], 8
    s_load_dwordx2 s[56:57], s[0:1], 0
    s_load_dwordx2 s[12:13], s[0:1], 16
    s_load_dwordx2 s[80:81], s[0:1], 32
    s_load_dwordx2 s[84:85], s[0:1], 48
    s_load_dwordx2 s[88:89], s[0:1], 56
    s_load_dwordx2 s[92:93], s[0:1], 80
    s_load_dwordx2 s[20:21], s[0:1], 72
    s_load_dwordx2 s[96:97], s[0:1], 64
    v_lshrrev_b32 v1, 6, v0
    s_nop 0
    v_readfirstlane_b32 s24, v1
    v_and_b32 v1, 63, v0
    s_and_b32 s25, s2, 7
    s_lshr_b32 s26, s2, 3
    v_lshrrev_b32 v40, 4, v1
    v_and_b32 v41, 15, v1
    v_and_b32 v42, 3, v1
    v_bfe_u32 v43, v1, 2, 2
    v_lshlrev_b32 v47, 4, v1
    s_mov_b32 s78, 0x400000
    s_mov_b32 s79, 0x20000
    s_mov_b32 s10, 0x8000000
    s_mov_b32 s11, 0x20000
    s_mov_b32 s58, 0x2000
    s_mov_b32 s59, 0x20000
    s_mov_b32 s14, 0x8000000
    s_mov_b32 s15, 0x20000
    s_mov_b32 s82, 0x400000
    s_mov_b32 s83, 0x20000
    s_mov_b32 s86, 0x1c0000
    s_mov_b32 s87, 0x20000
    s_mov_b32 s90, 0x1c0000
    s_mov_b32 s91, 0x20000
    s_mov_b32 s94, 0x20000000
    s_mov_b32 s95, 0x20000
    s_mov_b32 s22, 0x100
    s_mov_b32 s23, 0x20000
    s_mov_b32 s98, 0x2000
    s_mov_b32 s99, 0x20000
    s_cmp_ge_u32 s26, 28
    s_cbranch_scc1 L_service
    s_lshl_b32 s27, s25, 21
    s_mul_i32 s67, s26, 73728
    s_add_u32 s27, s27, s67
    s_lshl_b32 s54, s24, 10
    s_add_u32 s27, s27, s54
    s_and_b32 s67, s24, 1
    s_lshl_b32 s67, s67, 2
    v_add_u32 v44, s67, v40
    v_lshlrev_b32 v44, 1, v44
    v_xor_b32 v44, v44, v41
    v_lshlrev_b32 v44, 4, v44
    v_lshl_add_u32 v4, v40, 8, v44
    s_lshl_b32 s55, s26, 2
    s_add_u32 s55, s55, s24
    v_mov_b32 v128, v47
    v_lshrrev_b32 v44, 5, v1
    s_movk_i32 s70, 3584
    v_mul_lo_u32 v44, v44, s70
    v_and_b32 v45, 31, v1
    v_lshl_add_u32 v129, v45, 4, v44
    s_waitcnt lgkmcnt(0)
    s_lshl_b32 s67, s55, 13
    s_lshl_b32 s69, s25, 10
    s_add_u32 s67, s67, s69
    s_waitcnt lgkmcnt(0)
    buffer_load_dwordx4 v[64:67], v128, s[76:79], s67 offen
    s_add_u32 s67, s67, 917504
    buffer_load_dwordx4 v[64:67], v128, s[76:79], s67 offen
    s_add_u32 s67, s67, 917504
    buffer_load_dwordx4 v[64:67], v128, s[76:79], s67 offen
    s_add_u32 s67, s67, 917504
    buffer_load_dwordx4 v[64:67], v128, s[76:79], s67 offen
    s_add_u32 s67, s67, 917504
    buffer_load_dwordx4 v[64:67], v128, s[76:79], s67 offen
    s_add_u32 s67, s67, 917504
    s_mov_b32 s34, 0x8000000
    s_mov_b32 s35, 0x20000
    s_cmp_lt_u32 s26, 0
    s_cselect_b32 s41, 2, 1
    s_mov_b32 s32, s8
    s_mov_b32 s33, s9
    s_add_u32 s36, s27, 0
    s_add_u32 s37, s54, 0
    s_mov_b32 m0, s37
    s_add_u32 s37, s37, 4096
    buffer_load_dwordx4 v4, s[32:35], s36 offen nt lds
    s_add_u32 s36, s36, 4096
    s_mov_b32 m0, s37
    s_add_u32 s37, s37, 4096
    buffer_load_dwordx4 v4, s[32:35], s36 offen nt lds
    s_add_u32 s36, s36, 4096
    s_mov_b32 m0, s37
    s_add_u32 s37, s37, 4096
    buffer_load_dwordx4 v4, s[32:35], s36 offen nt lds
    s_add_u32 s36, s36, 4096
    s_mov_b32 m0, s37
    s_add_u32 s37, s37, 4096
    buffer_load_dwordx4 v4, s[32:35], s36 offen nt lds
    s_add_u32 s36, s36, 4096
    s_mov_b32 m0, s37
    s_add_u32 s37, s37, 4096
    buffer_load_dwordx4 v4, s[32:35], s36 offen nt lds
    s_add_u32 s36, s36, 4096
    s_lshl_b32 s67, s55, 10
    s_lshl_b32 s69, s25, 19
    s_add_u32 s69, s69, s67
    buffer_load_dwordx4 v[64:67], v128, s[80:83], s69 offen
    s_add_u32 s69, s69, 114688
    buffer_load_dwordx4 v[64:67], v128, s[80:83], s69 offen
    s_add_u32 s69, s69, 114688
    buffer_load_dwordx4 v[64:67], v128, s[80:83], s69 offen
    s_add_u32 s69, s69, 114688
    buffer_load_dwordx4 v[64:67], v128, s[80:83], s69 offen
    s_add_u32 s69, s69, 114688
    s_cmp_lt_u32 s55, 64
    s_cselect_b64 exec, -1, 0
    buffer_load_dwordx4 v[64:67], v128, s[80:83], s69 offen
    s_add_u32 s69, s69, 114688
    s_mov_b64 exec, -1
    s_mov_b32 m0, s37
    s_add_u32 s37, s37, 4096
    buffer_load_dwordx4 v4, s[32:35], s36 offen nt lds
    s_add_u32 s36, s36, 4096
    s_mov_b32 s29, 0x3e0293ee
    s_mov_b32 s56, 0x00ff00ff
    s_mov_b32 s57, 0x00ff00ff
    s_mov_b32 s58, 0xff00ff00
    s_mov_b32 s59, 0xff00ff00
    s_mov_b32 s60, 0x000f000f
    s_mov_b32 s61, 0
    s_mov_b32 s62, 0
    s_mov_b32 s63, 0x000f000f
    s_mov_b32 s66, 0x10000
    s_mov_b64 s[4:5], 0
    s_getreg_b32 s67, hwreg(HW_REG_XCC_ID, 0, 4)
    s_mul_i32 s68, s67, s67
    s_lshl_b32 s67, s67, 24
    s_or_b32 s72, s67, s68
    s_mov_b32 s73, 0x10000
    v_lshlrev_b32 v44, 8, v42
    v_lshl_add_u32 v13, v40, 4, v44
    s_mul_i32 s67, s26, 1024
    s_lshl_b32 s68, s24, 6
    s_add_u32 s68, s68, s67
    v_lshlrev_b32 v44, 8, v42
    v_lshl_add_u32 v44, v40, 3, v44
    v_and_b32 v45, 1, v43
    v_lshl_add_u32 v44, v45, 5, v44
    v_add_u32 v14, s68, v44
    s_lshl_b32 s68, s24, 3
    s_lshl_b32 s67, s26, 5
    s_add_u32 s68, s68, s67
    s_add_u32 s68, s68, 32768
    v_lshlrev_b32 v44, 10, v42
    v_add_u32 v15, s68, v44
    v_lshl_add_u32 v44, v40, 2, v43
    v_and_b32 v45, 7, v44
    s_lshl_b32 s67, s24, 1
    v_xor_b32 v45, s67, v45
    v_lshlrev_b32 v45, 5, v45
    v_lshl_add_u32 v45, v44, 8, v45
    v_lshl_add_u32 v5, v42, 3, v45
    v_lshl_add_u32 v44, v40, 3, v43
    v_xor_b32 v45, s67, v43
    v_lshlrev_b32 v45, 5, v45
    v_lshl_add_u32 v45, v44, 8, v45
    v_lshl_add_u32 v7, v42, 3, v45
    s_mul_i32 s67, s25, 415744
    s_add_u32 s67, s67, 1048576
    s_add_u32 s16, s92, s67
    s_addc_u32 s17, s93, 0
    s_mov_b32 s18, 415744
    s_mov_b32 s19, 0x20000
    v_mov_b32 v48, -1
    v_mov_b32 v49, -1
    v_mov_b32 v50, -1
    v_mov_b32 v51, -1
    s_lshl_b32 s68, s26, 2
    s_add_u32 s68, s68, s24
    s_mul_i32 s42, s68, 3712
    s_lshl_b32 s69, s68, 3
    s_add_u32 s69, s69, s25
    s_lshl_b32 s69, s69, 9
    buffer_store_dwordx4 v[48:51], v47, s[16:19], s42 offen offset:0 sc1
    buffer_store_dwordx4 v[48:51], v47, s[16:19], s42 offen offset:1024 sc1
    buffer_store_dwordx4 v[48:51], v47, s[16:19], s42 offen offset:2688 sc1
    buffer_store_dwordx4 v[48:51], v47, s[16:19], s42 offen offset:2048 sc1
    s_mov_b32 exec_hi, 0
    buffer_store_dwordx4 v[48:51], v47, s[92:95], s69 offen sc1
    s_mov_b64 exec, -1
    v_min_u32 v25, 28, v1
    v_lshlrev_b32 v25, 7, v25
    v_mov_b32 v63, 0xff800000
    v_and_b32 v46, 7, v41
    v_lshlrev_b32 v44, 1, v46
    v_xor_b32 v44, v44, v40
    v_lshlrev_b32 v44, 4, v44
    s_lshl_b32 s67, s24, 14
    v_lshl_add_u32 v45, v41, 8, v44
    v_add_u32 v2, s67, v45
    s_lshl_b32 s67, s24, 11
    s_add_u32 s67, s67, 65536
    v_lshl_add_u32 v45, v46, 8, v44
    v_add_u32 v3, s67, v45
    v_add_u32 v7, 139264, v7
    v_add_u32 v5, 73728, v5
    v_lshlrev_b32 v46, 6, v40
    v_lshl_add_u32 v46, v42, 4, v46
    s_lshl_b32 s67, s24, 9
    s_add_u32 s67, s67, 147456
    v_lshrrev_b32 v44, 1, v43
    v_lshl_add_u32 v44, v44, 8, v46
    v_and_b32 v45, 1, v43
    v_lshl_add_u32 v44, v45, 3, v44
    v_add_u32 v8, s67, v44
    s_lshl_b32 s67, s24, 6
    s_add_u32 s67, s67, 149504
    v_and_b32 v45, 1, v40
    v_lshlrev_b32 v45, 3, v45
    v_lshl_add_u32 v44, v42, 4, v45
    v_add_u32 v9, s67, v44
    s_lshl_b32 s67, s24, 4
    s_add_u32 s67, s67, 150528
    v_lshlrev_b32 v44, 2, v42
    v_add_u32 v10, s67, v44
    v_lshlrev_b32 v44, 2, v41
    v_add_u32 v11, 150528, v44
    v_mov_b32 v45, 150016
    v_add_u32 v44, 147456, v46
    v_cmp_eq_u32 vcc, 0, v43
    s_nop 1
    v_cndmask_b32 v12, v45, v44, vcc
    v_add_u32 v44, 147968, v46
    v_cmp_eq_u32 vcc, 1, v43
    s_nop 1
    v_cndmask_b32 v56, v45, v44, vcc
    v_add_u32 v44, 148480, v46
    v_cmp_eq_u32 vcc, 2, v43
    s_nop 1
    v_cndmask_b32 v57, v45, v44, vcc
    v_add_u32 v44, 148992, v46
    v_cmp_eq_u32 vcc, 3, v43
    s_nop 1
    v_cndmask_b32 v58, v45, v44, vcc
    v_add_u32 v44, 149504, v46
    v_cmp_eq_u32 vcc, v40, v43
    s_nop 1
    v_cndmask_b32 v59, v45, v44, vcc
    v_mov_b32 v52, 0
    v_mov_b32 v53, 0
    v_lshlrev_b32 v44, 3, v1
    v_add_u32 v44, 150016, v44
    ds_write_b64 v44, v[52:53]
    ds_write_b64 v44, v[52:53] offset:4096
    v_accvgpr_write_b32 a216, 0
    v_accvgpr_write_b32 a217, 0
    v_accvgpr_write_b32 a218, 0
    v_accvgpr_write_b32 a219, 0
    v_accvgpr_write_b32 a220, 0
    v_accvgpr_write_b32 a221, 0
    v_accvgpr_write_b32 a222, 0
    v_accvgpr_write_b32 a223, 0
    v_accvgpr_write_b32 a224, 0
    v_accvgpr_write_b32 a225, 0
    v_accvgpr_write_b32 a226, 0
    v_accvgpr_write_b32 a227, 0
    v_accvgpr_write_b32 a228, 0
    v_accvgpr_write_b32 a229, 0
    v_accvgpr_write_b32 a230, 0
    v_accvgpr_write_b32 a231, 0
    v_accvgpr_write_b32 a232, 0
    v_accvgpr_write_b32 a233, 0
    v_accvgpr_write_b32 a234, 0
    v_accvgpr_write_b32 a235, 0
    v_accvgpr_write_b32 a236, 0
    v_accvgpr_write_b32 a237, 0
    v_accvgpr_write_b32 a238, 0
    v_accvgpr_write_b32 a239, 0
    v_accvgpr_write_b32 a240, 0
    v_accvgpr_write_b32 a241, 0
    v_accvgpr_write_b32 a242, 0
    v_accvgpr_write_b32 a243, 0
    v_accvgpr_write_b32 a244, 0
    v_accvgpr_write_b32 a245, 0
    v_accvgpr_write_b32 a246, 0
    v_accvgpr_write_b32 a247, 0
    s_lshl_b32 s67, s24, 8
    v_lshlrev_b32 v44, 4, v41
    v_add_u32 v13, s67, v44
    v_lshl_add_u32 v24, v40, 10, v13
    s_mul_i32 s67, s24, 272
    s_add_u32 s67, s67, 155648
    v_add_u32 v6, s67, v44
    v_and_b32 v30, 7, v1
    v_lshlrev_b32 v30, 5, v30
    v_mul_u32_u24 v44, 272, v42
    v_lshl_add_u32 v44, v40, 4, v44
    v_add_u32 v1, 155648, v44
    s_waitcnt vmcnt(5)
    s_mov_b32 m0, s37
    s_add_u32 s37, s37, 4096
    buffer_load_dwordx4 v4, s[32:35], s36 offen nt lds
    s_add_u32 s36, s36, 4096
    s_add_u32 s67, s55, 0
    s_lshr_b32 s69, s67, 5
    s_lshl_b32 s69, s69, 24
    s_and_b32 s70, s67, 31
    s_lshl_b32 s70, s70, 10
    s_add_u32 s69, s69, s70
    s_lshl_b32 s70, s25, 21
    s_add_u32 s69, s69, s70
    s_add_u32 s69, s69, 2064384
    buffer_load_dwordx4 v[64:67], v128, s[8:11], s69 offen
    buffer_load_dwordx4 v[64:67], v128, s[12:15], s69 offen
    s_add_u32 s67, s55, 112
    s_lshr_b32 s69, s67, 5
    s_lshl_b32 s69, s69, 24
    s_and_b32 s70, s67, 31
    s_lshl_b32 s70, s70, 10
    s_add_u32 s69, s69, s70
    s_lshl_b32 s70, s25, 21
    s_add_u32 s69, s69, s70
    s_add_u32 s69, s69, 2064384
    buffer_load_dwordx4 v[64:67], v128, s[8:11], s69 offen
    buffer_load_dwordx4 v[64:67], v128, s[12:15], s69 offen
    s_add_u32 s67, s55, 224
    s_lshr_b32 s69, s67, 5
    s_lshl_b32 s69, s69, 24
    s_and_b32 s70, s67, 31
    s_lshl_b32 s70, s70, 10
    s_add_u32 s69, s69, s70
    s_lshl_b32 s70, s25, 21
    s_add_u32 s69, s69, s70
    s_add_u32 s69, s69, 2064384
    buffer_load_dwordx4 v[64:67], v128, s[8:11], s69 offen
    buffer_load_dwordx4 v[64:67], v128, s[12:15], s69 offen
    s_waitcnt vmcnt(5)
    s_mov_b32 m0, s37
    s_add_u32 s37, s37, 4096
    buffer_load_dwordx4 v4, s[32:35], s36 offen nt lds
    s_add_u32 s36, s36, 4096
    s_waitcnt vmcnt(5)
    s_mov_b32 m0, s37
    s_add_u32 s37, s37, 4096
    buffer_load_dwordx4 v4, s[32:35], s36 offen nt lds
    s_add_u32 s36, s36, 4096
    s_waitcnt vmcnt(5)
    s_mov_b32 m0, s37
    s_add_u32 s37, s37, 4096
    buffer_load_dwordx4 v4, s[32:35], s36 offen nt lds
    s_add_u32 s36, s36, 4096
    s_waitcnt vmcnt(10)
    buffer_load_dword v26, v25, s[16:19], s42 offen sc1
    s_waitcnt lgkmcnt(0)
    s_barrier
    v_mov_b32 v44, s72
    v_mov_b32 v45, s73
    s_lshl_b32 s67, s25, 5
    s_cmp_eq_u32 s24, 0
    s_cselect_b64 exec, 1, 0
    buffer_atomic_add_x2 v[44:45], off, s[20:23], s67 sc1
    s_mov_b64 exec, -1
    s_waitcnt vmcnt(5)
    s_mov_b32 m0, s37
    s_add_u32 s37, s37, 4096
    buffer_load_dwordx4 v4, s[32:35], s36 offen nt lds
    s_add_u32 s36, s36, 4096
    s_waitcnt vmcnt(5)
    s_mov_b32 m0, s37
    s_add_u32 s37, s37, 4096
    buffer_load_dwordx4 v4, s[32:35], s36 offen nt lds
    s_add_u32 s36, s36, 4096
    s_mul_i32 s69, s55, 7168
    s_mul_i32 s70, s25, 448
    s_and_b32 s70, s70, 0xffffff80
    s_add_u32 s69, s69, s70
    buffer_load_dwordx4 v[64:67], v129, s[84:87], s69 offen
    s_add_u32 s69, s69, 802816
    buffer_load_dwordx4 v[64:67], v129, s[84:87], s69 offen
    s_add_u32 s69, s69, 802816
    buffer_load_dwordx4 v[64:67], v129, s[84:87], s69 offen
    s_add_u32 s69, s69, 802816
    s_lshl_b32 s67, s55, 10
    s_mul_i32 s69, s25, 229376
    s_add_u32 s69, s69, s67
    buffer_load_dwordx4 v[64:67], v128, s[88:91], s69 offen
    s_add_u32 s69, s69, 114688
    buffer_load_dwordx4 v[64:67], v128, s[88:91], s69 offen
    s_add_u32 s69, s69, 114688
    s_waitcnt vmcnt(5)
    s_mov_b32 m0, s37
    s_add_u32 s37, s37, 4096
    buffer_load_dwordx4 v4, s[32:35], s36 offen nt lds
    s_add_u32 s36, s36, 4096
    s_waitcnt vmcnt(5)
    s_mov_b32 m0, s37
    s_add_u32 s37, s37, 4096
    buffer_load_dwordx4 v4, s[32:35], s36 offen nt lds
    s_add_u32 s36, s36, 4096
    s_waitcnt vmcnt(5)
    s_mov_b32 m0, s37
    s_add_u32 s37, s37, 4096
    buffer_load_dwordx4 v4, s[32:35], s36 offen nt lds
    s_add_u32 s36, s36, 4096
    s_waitcnt vmcnt(5)
    s_mov_b32 m0, s37
    s_add_u32 s37, s37, 4096
    buffer_load_dwordx4 v4, s[32:35], s36 offen nt lds
    s_add_u32 s36, s36, 4096
    s_waitcnt vmcnt(5)
    s_mov_b32 m0, s37
    s_add_u32 s37, s37, 4096
    buffer_load_dwordx4 v4, s[32:35], s36 offen nt lds
    s_add_u32 s36, s36, 4096
    s_waitcnt vmcnt(5)
    s_mov_b32 m0, s37
    s_add_u32 s37, s37, 4096
    buffer_load_dwordx4 v4, s[32:35], s36 offen nt lds
    s_add_u32 s36, s36, 4096
    s_waitcnt lgkmcnt(0)
    s_barrier
    s_mov_b32 s32, s12
    s_mov_b32 s33, s13
    s_add_u32 s36, s27, 0
    s_add_u32 s37, s54, 73728
    s_waitcnt vmcnt(5)
    s_mov_b32 m0, s37
    s_add_u32 s37, s37, 4096
    buffer_load_dwordx4 v4, s[32:35], s36 offen nt lds
    s_add_u32 s36, s36, 4096
    s_waitcnt vmcnt(5)
    s_mov_b32 m0, s37
    s_add_u32 s37, s37, 4096
    buffer_load_dwordx4 v4, s[32:35], s36 offen nt lds
    s_add_u32 s36, s36, 4096
    s_waitcnt vmcnt(5)
    s_mov_b32 m0, s37
    s_add_u32 s37, s37, 4096
    buffer_load_dwordx4 v4, s[32:35], s36 offen nt lds
    s_add_u32 s36, s36, 4096
    s_waitcnt vmcnt(5)
    s_mov_b32 m0, s37
    s_add_u32 s37, s37, 4096
    buffer_load_dwordx4 v4, s[32:35], s36 offen nt lds
    s_add_u32 s36, s36, 4096
    s_waitcnt vmcnt(5)
    s_mov_b32 m0, s37
    s_add_u32 s37, s37, 4096
    buffer_load_dwordx4 v4, s[32:35], s36 offen nt lds
    s_add_u32 s36, s36, 4096
    s_waitcnt vmcnt(5)
    s_mov_b32 m0, s37
    s_add_u32 s37, s37, 4096
    buffer_load_dwordx4 v4, s[32:35], s36 offen nt lds
    s_add_u32 s36, s36, 4096
    s_waitcnt vmcnt(5)
    s_mov_b32 m0, s37
    s_add_u32 s37, s37, 4096
    buffer_load_dwordx4 v4, s[32:35], s36 offen nt lds
    s_add_u32 s36, s36, 4096
    s_waitcnt vmcnt(5)
    s_mov_b32 m0, s37
    s_add_u32 s37, s37, 4096
    buffer_load_dwordx4 v4, s[32:35], s36 offen nt lds
    s_add_u32 s36, s36, 4096
    s_waitcnt vmcnt(8)
    s_barrier
    s_mov_b32 m0, s37
    s_add_u32 s37, s37, 4096
    buffer_load_dwordx4 v4, s[32:35], s36 offen nt lds
    s_add_u32 s36, s36, 4096
    s_mov_b32 m0, s37
    s_add_u32 s37, s37, 4096
    buffer_load_dwordx4 v4, s[32:35], s36 offen nt lds
    s_add_u32 s36, s36, 4096
    v_xor_b32 v53, 64, v2
    v_xor_b32 v54, 128, v2
    v_xor_b32 v55, 192, v2
    ds_read_b128 v[64:67], v2 offset:0
    ds_read_b128 v[68:71], v53 offset:0
    ds_read_b128 v[72:75], v54 offset:0
    ds_read_b128 v[76:79], v55 offset:0
    ds_read_b128 v[80:83], v2 offset:4096
    ds_read_b128 v[84:87], v53 offset:4096
    ds_read_b128 v[88:91], v54 offset:4096
    ds_read_b128 v[92:95], v55 offset:4096
    ds_read_b128 v[96:99], v2 offset:8192
    ds_read_b128 v[100:103], v53 offset:8192
    ds_read_b128 v[104:107], v54 offset:8192
    ds_read_b128 v[108:111], v55 offset:8192
    ds_read_b128 v[112:115], v2 offset:12288
    ds_read_b128 v[116:119], v53 offset:12288
    ds_read_b128 v[120:123], v54 offset:12288
    ds_read_b128 v[124:127], v55 offset:12288
    v_xor_b32 v53, 64, v3
    v_xor_b32 v54, 128, v3
    v_xor_b32 v55, 192, v3
    s_mov_b64 exec, s[56:57]
    ds_read_b128 a[216:219], v3 offset:0
    ds_read_b128 a[220:223], v53 offset:0
    ds_read_b128 a[224:227], v54 offset:0
    ds_read_b128 a[228:231], v55 offset:0
    s_mov_b64 exec, -1
    s_waitcnt vmcnt(5)
    s_mov_b32 m0, s37
    s_add_u32 s37, s37, 4096
    buffer_load_dwordx4 v4, s[32:35], s36 offen nt lds
    s_add_u32 s36, s36, 4096
    s_waitcnt vmcnt(5)
    s_mov_b32 m0, s37
    s_add_u32 s37, s37, 4096
    buffer_load_dwordx4 v4, s[32:35], s36 offen nt lds
    s_add_u32 s36, s36, 4096
    s_waitcnt vmcnt(5)
    s_mov_b32 m0, s37
    s_add_u32 s37, s37, 4096
    buffer_load_dwordx4 v4, s[32:35], s36 offen nt lds
    s_add_u32 s36, s36, 4096
    s_waitcnt vmcnt(5)
    s_mov_b32 m0, s37
    s_add_u32 s37, s37, 4096
    buffer_load_dwordx4 v4, s[32:35], s36 offen nt lds
    s_add_u32 s36, s36, 4096
    s_waitcnt vmcnt(5)
    s_mov_b32 m0, s37
    s_add_u32 s37, s37, 4096
    buffer_load_dwordx4 v4, s[32:35], s36 offen nt lds
    s_add_u32 s36, s36, 4096
    s_waitcnt vmcnt(5)
    s_mov_b32 m0, s37
    s_add_u32 s37, s37, 4096
    buffer_load_dwordx4 v4, s[32:35], s36 offen nt lds
    s_add_u32 s36, s36, 4096
    s_waitcnt vmcnt(5)
    s_mov_b32 m0, s37
    s_add_u32 s37, s37, 4096
    buffer_load_dwordx4 v4, s[32:35], s36 offen nt lds
    s_add_u32 s36, s36, 4096
    s_waitcnt vmcnt(5)
    s_mov_b32 m0, s37
    s_add_u32 s37, s37, 4096
    buffer_load_dwordx4 v4, s[32:35], s36 offen nt lds
    s_add_u32 s36, s36, 4096
    s_waitcnt lgkmcnt(0)
    s_barrier
    s_mov_b32 s32, s8
    s_mov_b32 s33, s9
    s_add_u32 s36, s27, 16777216
    s_add_u32 s37, s54, 0
    s_waitcnt vmcnt(5)
    s_mov_b32 m0, s37
    s_add_u32 s37, s37, 4096
    buffer_load_dwordx4 v4, s[32:35], s36 offen nt lds
    s_add_u32 s36, s36, 4096
    s_waitcnt vmcnt(5)
    s_mov_b32 m0, s37
    s_add_u32 s37, s37, 4096
    buffer_load_dwordx4 v4, s[32:35], s36 offen nt lds
    s_add_u32 s36, s36, 4096
    s_waitcnt vmcnt(5)
    s_mov_b32 m0, s37
    s_add_u32 s37, s37, 4096
    buffer_load_dwordx4 v4, s[32:35], s36 offen nt lds
    s_add_u32 s36, s36, 4096
    s_waitcnt vmcnt(5)
    s_mov_b32 m0, s37
    s_add_u32 s37, s37, 4096
    buffer_load_dwordx4 v4, s[32:35], s36 offen nt lds
    s_add_u32 s36, s36, 4096
    s_waitcnt vmcnt(5)
    s_mov_b32 m0, s37
    s_add_u32 s37, s37, 4096
    buffer_load_dwordx4 v4, s[32:35], s36 offen nt lds
    s_add_u32 s36, s36, 4096
    s_waitcnt vmcnt(5)
    s_mov_b32 m0, s37
    s_add_u32 s37, s37, 4096
    buffer_load_dwordx4 v4, s[32:35], s36 offen nt lds
    s_add_u32 s36, s36, 4096
    s_waitcnt vmcnt(5)
    s_mov_b32 m0, s37
    s_add_u32 s37, s37, 4096
    buffer_load_dwordx4 v4, s[32:35], s36 offen nt lds
    s_add_u32 s36, s36, 4096
    s_waitcnt vmcnt(5)
    s_mov_b32 m0, s37
    s_add_u32 s37, s37, 4096
    buffer_load_dwordx4 v4, s[32:35], s36 offen nt lds
    s_add_u32 s36, s36, 4096
    buffer_load_dwordx2 v[28:29], v30, s[20:23], 0 offen sc1
    s_waitcnt vmcnt(9)
    s_barrier
    s_mov_b32 m0, s37
    s_add_u32 s37, s37, 4096
    buffer_load_dwordx4 v4, s[32:35], s36 offen nt lds
    s_add_u32 s36, s36, 4096
    s_mov_b32 m0, s37
    s_add_u32 s37, s37, 4096
    buffer_load_dwordx4 v4, s[32:35], s36 offen nt lds
    s_add_u32 s36, s36, 4096
    v_xor_b32 v52, 32, v5
    ds_read_b64_tr_b16 a[0:1], v5 offset:0
    ds_read_b64_tr_b16 a[2:3], v5 offset:4096
    ds_read_b64_tr_b16 a[4:5], v52 offset:0
    ds_read_b64_tr_b16 a[6:7], v52 offset:4096
    ds_read_b64_tr_b16 a[8:9], v5 offset:8192
    ds_read_b64_tr_b16 a[10:11], v5 offset:12288
    ds_read_b64_tr_b16 a[12:13], v52 offset:8192
    ds_read_b64_tr_b16 a[14:15], v52 offset:12288
    ds_read_b64_tr_b16 a[16:17], v5 offset:16384
    ds_read_b64_tr_b16 a[18:19], v5 offset:20480
    ds_read_b64_tr_b16 a[20:21], v52 offset:16384
    ds_read_b64_tr_b16 a[22:23], v52 offset:20480
    ds_read_b64_tr_b16 a[24:25], v5 offset:24576
    ds_read_b64_tr_b16 a[26:27], v5 offset:28672
    ds_read_b64_tr_b16 a[28:29], v52 offset:24576
    ds_read_b64_tr_b16 a[30:31], v52 offset:28672
    ds_read_b64_tr_b16 a[32:33], v5 offset:32768
    ds_read_b64_tr_b16 a[34:35], v5 offset:36864
    ds_read_b64_tr_b16 a[36:37], v52 offset:32768
    ds_read_b64_tr_b16 a[38:39], v52 offset:36864
    ds_read_b64_tr_b16 a[40:41], v5 offset:40960
    ds_read_b64_tr_b16 a[42:43], v5 offset:45056
    ds_read_b64_tr_b16 a[44:45], v52 offset:40960
    ds_read_b64_tr_b16 a[46:47], v52 offset:45056
    ds_read_b64_tr_b16 a[48:49], v5 offset:49152
    ds_read_b64_tr_b16 a[50:51], v5 offset:53248
    ds_read_b64_tr_b16 a[52:53], v52 offset:49152
    ds_read_b64_tr_b16 a[54:55], v52 offset:53248
    ds_read_b64_tr_b16 a[56:57], v5 offset:57344
    ds_read_b64_tr_b16 a[58:59], v5 offset:61440
    ds_read_b64_tr_b16 a[60:61], v52 offset:57344
    ds_read_b64_tr_b16 a[62:63], v52 offset:61440
    v_xor_b32 v53, 32, v7
    v_xor_b32 v54, 128, v7
    v_xor_b32 v55, 160, v7
    ds_read_b64_tr_b16 a[64:65], v7
    ds_read_b64_tr_b16 a[66:67], v54 offset:1024
    ds_read_b64_tr_b16 a[68:69], v53
    ds_read_b64_tr_b16 a[70:71], v55 offset:1024
    s_waitcnt vmcnt(5)
    s_mov_b32 m0, s37
    s_add_u32 s37, s37, 4096
    buffer_load_dwordx4 v4, s[32:35], s36 offen nt lds
    s_add_u32 s36, s36, 4096
    s_waitcnt vmcnt(5)
    s_mov_b32 m0, s37
    s_add_u32 s37, s37, 4096
    buffer_load_dwordx4 v4, s[32:35], s36 offen nt lds
    s_add_u32 s36, s36, 4096
    s_waitcnt vmcnt(5)
    s_mov_b32 m0, s37
    s_add_u32 s37, s37, 4096
    buffer_load_dwordx4 v4, s[32:35], s36 offen nt lds
    s_add_u32 s36, s36, 4096
    s_waitcnt vmcnt(5)
    s_mov_b32 m0, s37
    s_add_u32 s37, s37, 4096
    buffer_load_dwordx4 v4, s[32:35], s36 offen nt lds
    s_add_u32 s36, s36, 4096
    s_waitcnt vmcnt(6)
    s_branch Lw_2
Lw_1:
    s_sub_u32 s66, s66, 1
    s_cbranch_scc1 L_end
    s_sleep 8
    buffer_load_dwordx2 v[28:29], v30, s[20:23], 0 offen sc1
    s_waitcnt vmcnt(0)
Lw_2:
    v_lshrrev_b32 v31, 16, v29
    v_cmp_ne_u32 vcc, 32, v31
    s_nop 0
    s_cbranch_vccnz Lw_1
    v_readlane_b32 s68, v28, s25
    v_readlane_b32 s69, v29, s25
    s_lshl_b64 s[72:73], s[72:73], 5
    s_cmp_eq_u64 s[68:69], s[72:73]
    s_cselect_b64 s[4:5], -1, 0
    s_mov_b32 s67, 4096
    buffer_load_dwordx4 v[16:19], v24, s[16:19], 0 offen sc1
    buffer_load_dwordx4 v[20:23], v24, s[16:19], s67 offen sc1
    s_waitcnt vmcnt(5)
    s_mov_b32 m0, s37
    s_add_u32 s37, s37, 4096
    buffer_load_dwordx4 v4, s[32:35], s36 offen nt lds
    s_add_u32 s36, s36, 4096
    s_waitcnt vmcnt(5)
    s_mov_b32 m0, s37
    s_add_u32 s37, s37, 4096
    buffer_load_dwordx4 v4, s[32:35], s36 offen nt lds
    s_add_u32 s36, s36, 4096
    s_waitcnt vmcnt(5)
    s_mov_b32 m0, s37
    s_add_u32 s37, s37, 4096
    buffer_load_dwordx4 v4, s[32:35], s36 offen nt lds
    s_add_u32 s36, s36, 4096
    s_waitcnt vmcnt(5)
    s_mov_b32 m0, s37
    s_add_u32 s37, s37, 4096
    buffer_load_dwordx4 v4, s[32:35], s36 offen nt lds
    s_add_u32 s36, s36, 4096
    s_waitcnt lgkmcnt(0)
    s_barrier
    s_mov_b32 s32, s12
    s_mov_b32 s33, s13
    s_add_u32 s36, s27, 16777216
    s_add_u32 s37, s54, 73728
    s_waitcnt vmcnt(5)
    s_mov_b32 m0, s37
    s_add_u32 s37, s37, 4096
    buffer_load_dwordx4 v4, s[32:35], s36 offen nt lds
    s_add_u32 s36, s36, 4096
    s_waitcnt vmcnt(5)
    s_mov_b32 m0, s37
    s_add_u32 s37, s37, 4096
    buffer_load_dwordx4 v4, s[32:35], s36 offen nt lds
    s_add_u32 s36, s36, 4096
    s_waitcnt vmcnt(6)
    s_branch Lq_4
Lq_3:
    s_sub_u32 s66, s66, 1
    s_cbranch_scc1 L_end
    s_mov_b32 s67, 4096
    buffer_load_dwordx4 v[16:19], v24, s[16:19], 0 offen sc1
    buffer_load_dwordx4 v[20:23], v24, s[16:19], s67 offen sc1
    s_waitcnt vmcnt(0)
Lq_4:
    v_max3_u32 v60, v16, v17, v18
    v_max3_u32 v61, v19, v20, v21
    v_max3_u32 v60, v60, v22, v23
    v_max_u32 v60, v60, v61
    v_cmp_eq_u32 vcc, -1, v60
    s_nop 0
    s_cbranch_vccnz Lq_3
    v_accvgpr_write_b32 a248, v16
    v_accvgpr_write_b32 a249, v17
    v_accvgpr_write_b32 a250, v18
    v_accvgpr_write_b32 a251, v19
    v_accvgpr_write_b32 a252, v20
    v_accvgpr_write_b32 a253, v21
    v_accvgpr_write_b32 a254, v22
    v_accvgpr_write_b32 a255, v23
    s_mov_b32 exec_lo, 0xffff
    s_mov_b32 exec_hi, 0x0
    ds_write_b128 v6, a[248:251]
    s_mov_b64 exec, -1
    s_waitcnt lgkmcnt(0)
    s_barrier
    s_mov_b32 m0, s37
    s_add_u32 s37, s37, 4096
    buffer_load_dwordx4 v4, s[32:35], s36 offen nt lds
    s_add_u32 s36, s36, 4096
    s_mov_b32 m0, s37
    s_add_u32 s37, s37, 4096
    buffer_load_dwordx4 v4, s[32:35], s36 offen nt lds
    s_add_u32 s36, s36, 4096
    s_mov_b32 m0, s37
    s_add_u32 s37, s37, 4096
    buffer_load_dwordx4 v4, s[32:35], s36 offen nt lds
    s_add_u32 s36, s36, 4096
    s_mov_b32 s38, 0
    s_call_b64 s[30:31], L_ar0
    s_mov_b32 m0, s37
    s_add_u32 s37, s37, 4096
    buffer_load_dwordx4 v4, s[32:35], s36 offen nt lds
    s_add_u32 s36, s36, 4096
    s_mov_b32 m0, s37
    s_add_u32 s37, s37, 4096
    buffer_load_dwordx4 v4, s[32:35], s36 offen nt lds
    s_add_u32 s36, s36, 4096
    s_mov_b32 m0, s37
    s_add_u32 s37, s37, 4096
    buffer_load_dwordx4 v4, s[32:35], s36 offen nt lds
    s_add_u32 s36, s36, 4096
    s_mov_b32 s64, 44160
    s_call_b64 s[30:31], L_b0
    s_waitcnt vmcnt(8)
    s_barrier
    s_mov_b32 m0, s37
    s_add_u32 s37, s37, 4096
    buffer_load_dwordx4 v4, s[32:35], s36 offen nt lds
    s_add_u32 s36, s36, 4096
    s_mov_b32 m0, s37
    s_add_u32 s37, s37, 4096
    buffer_load_dwordx4 v4, s[32:35], s36 offen nt lds
    s_add_u32 s36, s36, 4096
    v_xor_b32 v53, 64, v2
    v_xor_b32 v54, 128, v2
    v_xor_b32 v55, 192, v2
    ds_read_b128 v[128:131], v2 offset:0
    ds_read_b128 v[132:135], v53 offset:0
    ds_read_b128 v[136:139], v54 offset:0
    ds_read_b128 v[140:143], v55 offset:0
    ds_read_b128 v[144:147], v2 offset:4096
    ds_read_b128 v[148:151], v53 offset:4096
    ds_read_b128 v[152:155], v54 offset:4096
    ds_read_b128 v[156:159], v55 offset:4096
    ds_read_b128 v[160:163], v2 offset:8192
    ds_read_b128 v[164:167], v53 offset:8192
    ds_read_b128 v[168:171], v54 offset:8192
    ds_read_b128 v[172:175], v55 offset:8192
    ds_read_b128 v[176:179], v2 offset:12288
    ds_read_b128 v[180:183], v53 offset:12288
    ds_read_b128 v[184:187], v54 offset:12288
    ds_read_b128 v[188:191], v55 offset:12288
    v_xor_b32 v53, 64, v3
    v_xor_b32 v54, 128, v3
    v_xor_b32 v55, 192, v3
    s_mov_b64 exec, s[58:59]
    ds_read_b128 a[216:219], v3 offset:0
    ds_read_b128 a[220:223], v53 offset:0
    ds_read_b128 a[224:227], v54 offset:0
    ds_read_b128 a[228:231], v55 offset:0
    s_mov_b64 exec, -1
    s_waitcnt vmcnt(5)
    s_mov_b32 m0, s37
    s_add_u32 s37, s37, 4096
    buffer_load_dwordx4 v4, s[32:35], s36 offen nt lds
    s_add_u32 s36, s36, 4096
    s_waitcnt vmcnt(5)
    s_mov_b32 m0, s37
    s_add_u32 s37, s37, 4096
    buffer_load_dwordx4 v4, s[32:35], s36 offen nt lds
    s_add_u32 s36, s36, 4096
    s_waitcnt vmcnt(5)
    s_mov_b32 m0, s37
    s_add_u32 s37, s37, 4096
    buffer_load_dwordx4 v4, s[32:35], s36 offen nt lds
    s_add_u32 s36, s36, 4096
    s_waitcnt vmcnt(5)
    s_mov_b32 m0, s37
    s_add_u32 s37, s37, 4096
    buffer_load_dwordx4 v4, s[32:35], s36 offen nt lds
    s_add_u32 s36, s36, 4096
    s_waitcnt vmcnt(5)
    s_mov_b32 m0, s37
    s_add_u32 s37, s37, 4096
    buffer_load_dwordx4 v4, s[32:35], s36 offen nt lds
    s_add_u32 s36, s36, 4096
    s_waitcnt vmcnt(5)
    s_mov_b32 m0, s37
    s_add_u32 s37, s37, 4096
    buffer_load_dwordx4 v4, s[32:35], s36 offen nt lds
    s_add_u32 s36, s36, 4096
    s_waitcnt vmcnt(5)
    s_mov_b32 m0, s37
    s_add_u32 s37, s37, 4096
    buffer_load_dwordx4 v4, s[32:35], s36 offen nt lds
    s_add_u32 s36, s36, 4096
    s_waitcnt vmcnt(5)
    s_mov_b32 m0, s37
    s_add_u32 s37, s37, 4096
    buffer_load_dwordx4 v4, s[32:35], s36 offen nt lds
    s_add_u32 s36, s36, 4096
    s_mov_b32 exec_lo, 0xffff0000
    s_mov_b32 exec_hi, 0x0
    ds_write_b128 v6, a[248:251]
    s_mov_b64 exec, -1
    s_waitcnt lgkmcnt(0)
    s_barrier
    s_mov_b32 s32, s8
    s_mov_b32 s33, s9
    s_add_u32 s36, s27, 33554432
    s_add_u32 s37, s54, 0
    s_waitcnt vmcnt(5)
    s_mov_b32 m0, s37
    s_add_u32 s37, s37, 4096
    buffer_load_dwordx4 v4, s[32:35], s36 offen nt lds
    s_add_u32 s36, s36, 4096
    s_mov_b32 m0, s37
    s_add_u32 s37, s37, 4096
    buffer_load_dwordx4 v4, s[32:35], s36 offen nt lds
    s_add_u32 s36, s36, 4096
    s_mov_b32 m0, s37
    s_add_u32 s37, s37, 4096
    buffer_load_dwordx4 v4, s[32:35], s36 offen nt lds
    s_add_u32 s36, s36, 4096
    s_mov_b32 m0, s37
    s_add_u32 s37, s37, 4096
    buffer_load_dwordx4 v4, s[32:35], s36 offen nt lds
    s_add_u32 s36, s36, 4096
    s_mov_b32 s38, 0
    s_call_b64 s[30:31], L_ar1
    s_waitcnt vmcnt(5)
    s_mov_b32 m0, s37
    s_add_u32 s37, s37, 4096
    buffer_load_dwordx4 v4, s[32:35], s36 offen nt lds
    s_add_u32 s36, s36, 4096
    s_waitcnt vmcnt(5)
    s_mov_b32 m0, s37
    s_add_u32 s37, s37, 4096
    buffer_load_dwordx4 v4, s[32:35], s36 offen nt lds
    s_add_u32 s36, s36, 4096
    s_waitcnt vmcnt(5)
    s_mov_b32 m0, s37
    s_add_u32 s37, s37, 4096
    buffer_load_dwordx4 v4, s[32:35], s36 offen nt lds
    s_add_u32 s36, s36, 4096
    s_waitcnt vmcnt(5)
    s_mov_b32 m0, s37
    s_add_u32 s37, s37, 4096
    buffer_load_dwordx4 v4, s[32:35], s36 offen nt lds
    s_add_u32 s36, s36, 4096
    s_waitcnt vmcnt(8)
    s_barrier
    s_mov_b32 m0, s37
    s_add_u32 s37, s37, 4096
    buffer_load_dwordx4 v4, s[32:35], s36 offen nt lds
    s_add_u32 s36, s36, 4096
    s_mov_b32 m0, s37
    s_add_u32 s37, s37, 4096
    buffer_load_dwordx4 v4, s[32:35], s36 offen nt lds
    s_add_u32 s36, s36, 4096
    v_xor_b32 v52, 32, v5
    ds_read_b64_tr_b16 a[72:73], v5 offset:0
    ds_read_b64_tr_b16 a[74:75], v5 offset:4096
    ds_read_b64_tr_b16 a[76:77], v52 offset:0
    ds_read_b64_tr_b16 a[78:79], v52 offset:4096
    ds_read_b64_tr_b16 a[80:81], v5 offset:8192
    ds_read_b64_tr_b16 a[82:83], v5 offset:12288
    ds_read_b64_tr_b16 a[84:85], v52 offset:8192
    ds_read_b64_tr_b16 a[86:87], v52 offset:12288
    ds_read_b64_tr_b16 a[88:89], v5 offset:16384
    ds_read_b64_tr_b16 a[90:91], v5 offset:20480
    ds_read_b64_tr_b16 a[92:93], v52 offset:16384
    ds_read_b64_tr_b16 a[94:95], v52 offset:20480
    ds_read_b64_tr_b16 a[96:97], v5 offset:24576
    ds_read_b64_tr_b16 a[98:99], v5 offset:28672
    ds_read_b64_tr_b16 a[100:101], v52 offset:24576
    ds_read_b64_tr_b16 a[102:103], v52 offset:28672
    ds_read_b64_tr_b16 a[104:105], v5 offset:32768
    ds_read_b64_tr_b16 a[106:107], v5 offset:36864
    ds_read_b64_tr_b16 a[108:109], v52 offset:32768
    ds_read_b64_tr_b16 a[110:111], v52 offset:36864
    ds_read_b64_tr_b16 a[112:113], v5 offset:40960
    ds_read_b64_tr_b16 a[114:115], v5 offset:45056
    ds_read_b64_tr_b16 a[116:117], v52 offset:40960
    ds_read_b64_tr_b16 a[118:119], v52 offset:45056
    ds_read_b64_tr_b16 a[120:121], v5 offset:49152
    ds_read_b64_tr_b16 a[122:123], v5 offset:53248
    ds_read_b64_tr_b16 a[124:125], v52 offset:49152
    ds_read_b64_tr_b16 a[126:127], v52 offset:53248
    ds_read_b64_tr_b16 a[128:129], v5 offset:57344
    ds_read_b64_tr_b16 a[130:131], v5 offset:61440
    ds_read_b64_tr_b16 a[132:133], v52 offset:57344
    ds_read_b64_tr_b16 a[134:135], v52 offset:61440
    v_xor_b32 v53, 32, v7
    v_xor_b32 v54, 128, v7
    v_xor_b32 v55, 160, v7
    ds_read_b64_tr_b16 a[136:137], v7
    ds_read_b64_tr_b16 a[138:139], v54 offset:1024
    ds_read_b64_tr_b16 a[140:141], v53
    ds_read_b64_tr_b16 a[142:143], v55 offset:1024
    s_mov_b32 m0, s37
    s_add_u32 s37, s37, 4096
    buffer_load_dwordx4 v4, s[32:35], s36 offen nt lds
    s_add_u32 s36, s36, 4096
    s_mov_b32 m0, s37
    s_add_u32 s37, s37, 4096
    buffer_load_dwordx4 v4, s[32:35], s36 offen nt lds
    s_add_u32 s36, s36, 4096
    s_mov_b32 m0, s37
    s_add_u32 s37, s37, 4096
    buffer_load_dwordx4 v4, s[32:35], s36 offen nt lds
    s_add_u32 s36, s36, 4096
    s_mov_b32 s64, 81024
    s_call_b64 s[30:31], L_b1
    s_waitcnt vmcnt(5)
    s_mov_b32 m0, s37
    s_add_u32 s37, s37, 4096
    buffer_load_dwordx4 v4, s[32:35], s36 offen nt lds
    s_add_u32 s36, s36, 4096
    s_waitcnt vmcnt(5)
    s_mov_b32 m0, s37
    s_add_u32 s37, s37, 4096
    buffer_load_dwordx4 v4, s[32:35], s36 offen nt lds
    s_add_u32 s36, s36, 4096
    s_waitcnt vmcnt(5)
    s_mov_b32 m0, s37
    s_add_u32 s37, s37, 4096
    buffer_load_dwordx4 v4, s[32:35], s36 offen nt lds
    s_add_u32 s36, s36, 4096
    s_waitcnt vmcnt(5)
    s_mov_b32 m0, s37
    s_add_u32 s37, s37, 4096
    buffer_load_dwordx4 v4, s[32:35], s36 offen nt lds
    s_add_u32 s36, s36, 4096
    s_waitcnt vmcnt(5)
    s_mov_b32 m0, s37
    s_add_u32 s37, s37, 4096
    buffer_load_dwordx4 v4, s[32:35], s36 offen nt lds
    s_add_u32 s36, s36, 4096
    s_waitcnt lgkmcnt(0)
    s_barrier
    s_mov_b32 s32, s12
    s_mov_b32 s33, s13
    s_add_u32 s36, s27, 33554432
    s_add_u32 s37, s54, 73728
    s_waitcnt vmcnt(5)
    s_mov_b32 m0, s37
    s_add_u32 s37, s37, 4096
    buffer_load_dwordx4 v4, s[32:35], s36 offen nt lds
    s_add_u32 s36, s36, 4096
    s_waitcnt vmcnt(5)
    s_mov_b32 m0, s37
    s_add_u32 s37, s37, 4096
    buffer_load_dwordx4 v4, s[32:35], s36 offen nt lds
    s_add_u32 s36, s36, 4096
    s_waitcnt vmcnt(5)
    s_mov_b32 m0, s37
    s_add_u32 s37, s37, 4096
    buffer_load_dwordx4 v4, s[32:35], s36 offen nt lds
    s_add_u32 s36, s36, 4096
    s_waitcnt vmcnt(5)
    s_mov_b32 m0, s37
    s_add_u32 s37, s37, 4096
    buffer_load_dwordx4 v4, s[32:35], s36 offen nt lds
    s_add_u32 s36, s36, 4096
    s_waitcnt vmcnt(5)
    s_mov_b32 m0, s37
    s_add_u32 s37, s37, 4096
    buffer_load_dwordx4 v4, s[32:35], s36 offen nt lds
    s_add_u32 s36, s36, 4096
    s_waitcnt vmcnt(5)
    s_mov_b32 m0, s37
    s_add_u32 s37, s37, 4096
    buffer_load_dwordx4 v4, s[32:35], s36 offen nt lds
    s_add_u32 s36, s36, 4096
    s_waitcnt vmcnt(5)
    s_mov_b32 m0, s37
    s_add_u32 s37, s37, 4096
    buffer_load_dwordx4 v4, s[32:35], s36 offen nt lds
    s_add_u32 s36, s36, 4096
    s_waitcnt vmcnt(5)
    s_mov_b32 m0, s37
    s_add_u32 s37, s37, 4096
    buffer_load_dwordx4 v4, s[32:35], s36 offen nt lds
    s_add_u32 s36, s36, 4096
    s_waitcnt vmcnt(8)
    s_barrier
    s_mov_b32 m0, s37
    s_add_u32 s37, s37, 4096
    buffer_load_dwordx4 v4, s[32:35], s36 offen nt lds
    s_add_u32 s36, s36, 4096
    s_mov_b32 m0, s37
    s_add_u32 s37, s37, 4096
    buffer_load_dwordx4 v4, s[32:35], s36 offen nt lds
    s_add_u32 s36, s36, 4096
    v_xor_b32 v53, 64, v2
    v_xor_b32 v54, 128, v2
    v_xor_b32 v55, 192, v2
    ds_read_b128 v[192:195], v2 offset:0
    ds_read_b128 v[196:199], v53 offset:0
    ds_read_b128 v[200:203], v54 offset:0
    ds_read_b128 v[204:207], v55 offset:0
    ds_read_b128 v[208:211], v2 offset:4096
    ds_read_b128 v[212:215], v53 offset:4096
    ds_read_b128 v[216:219], v54 offset:4096
    ds_read_b128 v[220:223], v55 offset:4096
    ds_read_b128 v[224:227], v2 offset:8192
    ds_read_b128 v[228:231], v53 offset:8192
    ds_read_b128 v[232:235], v54 offset:8192
    ds_read_b128 v[236:239], v55 offset:8192
    ds_read_b128 v[240:243], v2 offset:12288
    ds_read_b128 v[244:247], v53 offset:12288
    ds_read_b128 v[248:251], v54 offset:12288
    ds_read_b128 v[252:255], v55 offset:12288
    v_xor_b32 v53, 64, v3
    v_xor_b32 v54, 128, v3
    v_xor_b32 v55, 192, v3
    s_mov_b64 exec, s[56:57]
    ds_read_b128 a[232:235], v3 offset:0
    ds_read_b128 a[236:239], v53 offset:0
    ds_read_b128 a[240:243], v54 offset:0
    ds_read_b128 a[244:247], v55 offset:0
    s_mov_b64 exec, -1
    s_waitcnt vmcnt(5)
    s_mov_b32 m0, s37
    s_add_u32 s37, s37, 4096
    buffer_load_dwordx4 v4, s[32:35], s36 offen nt lds
    s_add_u32 s36, s36, 4096
    s_waitcnt vmcnt(5)
    s_mov_b32 m0, s37
    s_add_u32 s37, s37, 4096
    buffer_load_dwordx4 v4, s[32:35], s36 offen nt lds
    s_add_u32 s36, s36, 4096
    s_waitcnt vmcnt(5)
    s_mov_b32 m0, s37
    s_add_u32 s37, s37, 4096
    buffer_load_dwordx4 v4, s[32:35], s36 offen nt lds
    s_add_u32 s36, s36, 4096
    s_waitcnt vmcnt(5)
    s_mov_b32 m0, s37
    s_add_u32 s37, s37, 4096
    buffer_load_dwordx4 v4, s[32:35], s36 offen nt lds
    s_add_u32 s36, s36, 4096
    s_waitcnt vmcnt(5)
    s_mov_b32 m0, s37
    s_add_u32 s37, s37, 4096
    buffer_load_dwordx4 v4, s[32:35], s36 offen nt lds
    s_add_u32 s36, s36, 4096
    s_waitcnt vmcnt(5)
    s_mov_b32 m0, s37
    s_add_u32 s37, s37, 4096
    buffer_load_dwordx4 v4, s[32:35], s36 offen nt lds
    s_add_u32 s36, s36, 4096
    s_waitcnt vmcnt(5)
    s_mov_b32 m0, s37
    s_add_u32 s37, s37, 4096
    buffer_load_dwordx4 v4, s[32:35], s36 offen nt lds
    s_add_u32 s36, s36, 4096
    s_waitcnt vmcnt(5)
    s_mov_b32 m0, s37
    s_add_u32 s37, s37, 4096
    buffer_load_dwordx4 v4, s[32:35], s36 offen nt lds
    s_add_u32 s36, s36, 4096
    s_mov_b32 exec_lo, 0x0
    s_mov_b32 exec_hi, 0xffff
    ds_write_b128 v6, a[248:251]
    s_mov_b64 exec, -1
    s_waitcnt lgkmcnt(0)
    s_barrier
    s_mov_b32 s32, s8
    s_mov_b32 s33, s9
    s_add_u32 s36, s27, 50331648
    s_add_u32 s37, s54, 0
    s_waitcnt vmcnt(5)
    s_mov_b32 m0, s37
    s_add_u32 s37, s37, 4096
    buffer_load_dwordx4 v4, s[32:35], s36 offen nt lds
    s_add_u32 s36, s36, 4096
    s_mov_b32 m0, s37
    s_add_u32 s37, s37, 4096
    buffer_load_dwordx4 v4, s[32:35], s36 offen nt lds
    s_add_u32 s36, s36, 4096
    s_mov_b32 m0, s37
    s_add_u32 s37, s37, 4096
    buffer_load_dwordx4 v4, s[32:35], s36 offen nt lds
    s_add_u32 s36, s36, 4096
    s_mov_b32 m0, s37
    s_add_u32 s37, s37, 4096
    buffer_load_dwordx4 v4, s[32:35], s36 offen nt lds
    s_add_u32 s36, s36, 4096
    s_mov_b32 s38, 0
    s_call_b64 s[30:31], L_ar2
    s_waitcnt vmcnt(5)
    s_mov_b32 m0, s37
    s_add_u32 s37, s37, 4096
    buffer_load_dwordx4 v4, s[32:35], s36 offen nt lds
    s_add_u32 s36, s36, 4096
    s_waitcnt vmcnt(5)
    s_mov_b32 m0, s37
    s_add_u32 s37, s37, 4096
    buffer_load_dwordx4 v4, s[32:35], s36 offen nt lds
    s_add_u32 s36, s36, 4096
    s_waitcnt vmcnt(5)
    s_mov_b32 m0, s37
    s_add_u32 s37, s37, 4096
    buffer_load_dwordx4 v4, s[32:35], s36 offen nt lds
    s_add_u32 s36, s36, 4096
    s_waitcnt vmcnt(5)
    s_mov_b32 m0, s37
    s_add_u32 s37, s37, 4096
    buffer_load_dwordx4 v4, s[32:35], s36 offen nt lds
    s_add_u32 s36, s36, 4096
    s_waitcnt vmcnt(8)
    s_barrier
    s_mov_b32 m0, s37
    s_add_u32 s37, s37, 4096
    buffer_load_dwordx4 v4, s[32:35], s36 offen nt lds
    s_add_u32 s36, s36, 4096
    s_mov_b32 m0, s37
    s_add_u32 s37, s37, 4096
    buffer_load_dwordx4 v4, s[32:35], s36 offen nt lds
    s_add_u32 s36, s36, 4096
    v_xor_b32 v52, 32, v5
    ds_read_b64_tr_b16 a[144:145], v5 offset:0
    ds_read_b64_tr_b16 a[146:147], v5 offset:4096
    ds_read_b64_tr_b16 a[148:149], v52 offset:0
    ds_read_b64_tr_b16 a[150:151], v52 offset:4096
    ds_read_b64_tr_b16 a[152:153], v5 offset:8192
    ds_read_b64_tr_b16 a[154:155], v5 offset:12288
    ds_read_b64_tr_b16 a[156:157], v52 offset:8192
    ds_read_b64_tr_b16 a[158:159], v52 offset:12288
    ds_read_b64_tr_b16 a[160:161], v5 offset:16384
    ds_read_b64_tr_b16 a[162:163], v5 offset:20480
    ds_read_b64_tr_b16 a[164:165], v52 offset:16384
    ds_read_b64_tr_b16 a[166:167], v52 offset:20480
    ds_read_b64_tr_b16 a[168:169], v5 offset:24576
    ds_read_b64_tr_b16 a[170:171], v5 offset:28672
    ds_read_b64_tr_b16 a[172:173], v52 offset:24576
    ds_read_b64_tr_b16 a[174:175], v52 offset:28672
    ds_read_b64_tr_b16 a[176:177], v5 offset:32768
    ds_read_b64_tr_b16 a[178:179], v5 offset:36864
    ds_read_b64_tr_b16 a[180:181], v52 offset:32768
    ds_read_b64_tr_b16 a[182:183], v52 offset:36864
    ds_read_b64_tr_b16 a[184:185], v5 offset:40960
    ds_read_b64_tr_b16 a[186:187], v5 offset:45056
    ds_read_b64_tr_b16 a[188:189], v52 offset:40960
    ds_read_b64_tr_b16 a[190:191], v52 offset:45056
    ds_read_b64_tr_b16 a[192:193], v5 offset:49152
    ds_read_b64_tr_b16 a[194:195], v5 offset:53248
    ds_read_b64_tr_b16 a[196:197], v52 offset:49152
    ds_read_b64_tr_b16 a[198:199], v52 offset:53248
    ds_read_b64_tr_b16 a[200:201], v5 offset:57344
    ds_read_b64_tr_b16 a[202:203], v5 offset:61440
    ds_read_b64_tr_b16 a[204:205], v52 offset:57344
    ds_read_b64_tr_b16 a[206:207], v52 offset:61440
    v_xor_b32 v53, 32, v7
    v_xor_b32 v54, 128, v7
    v_xor_b32 v55, 160, v7
    ds_read_b64_tr_b16 a[208:209], v7
    ds_read_b64_tr_b16 a[210:211], v54 offset:1024
    ds_read_b64_tr_b16 a[212:213], v53
    ds_read_b64_tr_b16 a[214:215], v55 offset:1024
    s_mov_b32 m0, s37
    s_add_u32 s37, s37, 4096
    buffer_load_dwordx4 v4, s[32:35], s36 offen nt lds
    s_add_u32 s36, s36, 4096
    s_mov_b32 m0, s37
    s_add_u32 s37, s37, 4096
    buffer_load_dwordx4 v4, s[32:35], s36 offen nt lds
    s_add_u32 s36, s36, 4096
    s_mov_b32 m0, s37
    s_add_u32 s37, s37, 4096
    buffer_load_dwordx4 v4, s[32:35], s36 offen nt lds
    s_add_u32 s36, s36, 4096
    s_mov_b32 s64, 117888
    s_call_b64 s[30:31], L_b2
    s_waitcnt vmcnt(5)
    s_mov_b32 m0, s37
    s_add_u32 s37, s37, 4096
    buffer_load_dwordx4 v4, s[32:35], s36 offen nt lds
    s_add_u32 s36, s36, 4096
    s_waitcnt vmcnt(5)
    s_mov_b32 m0, s37
    s_add_u32 s37, s37, 4096
    buffer_load_dwordx4 v4, s[32:35], s36 offen nt lds
    s_add_u32 s36, s36, 4096
    s_waitcnt vmcnt(5)
    s_mov_b32 m0, s37
    s_add_u32 s37, s37, 4096
    buffer_load_dwordx4 v4, s[32:35], s36 offen nt lds
    s_add_u32 s36, s36, 4096
    s_waitcnt vmcnt(5)
    s_mov_b32 m0, s37
    s_add_u32 s37, s37, 4096
    buffer_load_dwordx4 v4, s[32:35], s36 offen nt lds
    s_add_u32 s36, s36, 4096
    s_waitcnt vmcnt(5)
    s_mov_b32 m0, s37
    s_add_u32 s37, s37, 4096
    buffer_load_dwordx4 v4, s[32:35], s36 offen nt lds
    s_add_u32 s36, s36, 4096
    s_waitcnt lgkmcnt(0)
    s_barrier
    s_mov_b32 s32, s12
    s_mov_b32 s33, s13
    s_add_u32 s36, s27, 50331648
    s_add_u32 s37, s54, 73728
    s_waitcnt vmcnt(5)
    s_mov_b32 m0, s37
    s_add_u32 s37, s37, 4096
    buffer_load_dwordx4 v4, s[32:35], s36 offen nt lds
    s_add_u32 s36, s36, 4096
    s_waitcnt vmcnt(5)
    s_mov_b32 m0, s37
    s_add_u32 s37, s37, 4096
    buffer_load_dwordx4 v4, s[32:35], s36 offen nt lds
    s_add_u32 s36, s36, 4096
    s_waitcnt vmcnt(5)
    s_mov_b32 m0, s37
    s_add_u32 s37, s37, 4096
    buffer_load_dwordx4 v4, s[32:35], s36 offen nt lds
    s_add_u32 s36, s36, 4096
    s_waitcnt vmcnt(5)
    s_mov_b32 m0, s37
    s_add_u32 s37, s37, 4096
    buffer_load_dwordx4 v4, s[32:35], s36 offen nt lds
    s_add_u32 s36, s36, 4096
    s_waitcnt vmcnt(5)
    s_mov_b32 m0, s37
    s_add_u32 s37, s37, 4096
    buffer_load_dwordx4 v4, s[32:35], s36 offen nt lds
    s_add_u32 s36, s36, 4096
    s_waitcnt vmcnt(5)
    s_mov_b32 m0, s37
    s_add_u32 s37, s37, 4096
    buffer_load_dwordx4 v4, s[32:35], s36 offen nt lds
    s_add_u32 s36, s36, 4096
    s_waitcnt vmcnt(5)
    s_mov_b32 m0, s37
    s_add_u32 s37, s37, 4096
    buffer_load_dwordx4 v4, s[32:35], s36 offen nt lds
    s_add_u32 s36, s36, 4096
    s_waitcnt vmcnt(5)
    s_mov_b32 m0, s37
    s_add_u32 s37, s37, 4096
    buffer_load_dwordx4 v4, s[32:35], s36 offen nt lds
    s_add_u32 s36, s36, 4096
    s_mov_b32 s65, 8192
    buffer_load_dwordx4 v[44:47], v13, s[16:19], s65 offen sc1
    s_waitcnt vmcnt(5)
    s_mov_b32 m0, s37
    s_add_u32 s37, s37, 4096
    buffer_load_dwordx4 v4, s[32:35], s36 offen nt lds
    s_add_u32 s36, s36, 4096
    s_waitcnt vmcnt(5)
    s_mov_b32 m0, s37
    s_add_u32 s37, s37, 4096
    buffer_load_dwordx4 v4, s[32:35], s36 offen nt lds
    s_add_u32 s36, s36, 4096
    s_waitcnt vmcnt(5)
    s_mov_b32 m0, s37
    s_add_u32 s37, s37, 4096
    buffer_load_dwordx4 v4, s[32:35], s36 offen nt lds
    s_add_u32 s36, s36, 4096
    s_waitcnt vmcnt(5)
    s_mov_b32 m0, s37
    s_add_u32 s37, s37, 4096
    buffer_load_dwordx4 v4, s[32:35], s36 offen nt lds
    s_add_u32 s36, s36, 4096
    s_waitcnt vmcnt(5)
    s_mov_b32 m0, s37
    s_add_u32 s37, s37, 4096
    buffer_load_dwordx4 v4, s[32:35], s36 offen nt lds
    s_add_u32 s36, s36, 4096
    s_waitcnt vmcnt(14)
    s_waitcnt vmcnt(5)
    s_mov_b32 m0, s37
    s_add_u32 s37, s37, 4096
    buffer_load_dwordx4 v4, s[32:35], s36 offen nt lds
    s_add_u32 s36, s36, 4096
    s_mov_b32 m0, s37
    s_add_u32 s37, s37, 4096
    buffer_load_dwordx4 v4, s[32:35], s36 offen nt lds
    s_add_u32 s36, s36, 4096
    s_mov_b32 m0, s37
    s_add_u32 s37, s37, 4096
    buffer_load_dwordx4 v4, s[32:35], s36 offen nt lds
    s_add_u32 s36, s36, 4096
    s_mov_b32 s38, 0
    s_call_b64 s[30:31], L_a0
    s_mov_b32 m0, s37
    s_add_u32 s37, s37, 4096
    buffer_load_dwordx4 v4, s[32:35], s36 offen nt lds
    s_add_u32 s36, s36, 4096
    s_mov_b32 m0, s37
    s_add_u32 s37, s37, 4096
    buffer_load_dwordx4 v4, s[32:35], s36 offen nt lds
    s_add_u32 s36, s36, 4096
    v_xor_b32 v53, 64, v2
    v_xor_b32 v54, 128, v2
    v_xor_b32 v55, 192, v2
    ds_read_b128 v[64:67], v2 offset:0
    ds_read_b128 v[68:71], v53 offset:0
    ds_read_b128 v[72:75], v54 offset:0
    ds_read_b128 v[76:79], v55 offset:0
    ds_read_b128 v[80:83], v2 offset:4096
    ds_read_b128 v[84:87], v53 offset:4096
    ds_read_b128 v[88:91], v54 offset:4096
    ds_read_b128 v[92:95], v55 offset:4096
    ds_read_b128 v[96:99], v2 offset:8192
    ds_read_b128 v[100:103], v53 offset:8192
    ds_read_b128 v[104:107], v54 offset:8192
    ds_read_b128 v[108:111], v55 offset:8192
    ds_read_b128 v[112:115], v2 offset:12288
    ds_read_b128 v[116:119], v53 offset:12288
    ds_read_b128 v[120:123], v54 offset:12288
    ds_read_b128 v[124:127], v55 offset:12288
    v_xor_b32 v53, 64, v3
    v_xor_b32 v54, 128, v3
    v_xor_b32 v55, 192, v3
    s_mov_b64 exec, s[56:57]
    ds_read_b128 a[216:219], v3 offset:0
    ds_read_b128 a[220:223], v53 offset:0
    ds_read_b128 a[224:227], v54 offset:0
    ds_read_b128 a[228:231], v55 offset:0
    s_mov_b64 exec, -1
    s_mov_b32 exec_lo, 0x0
    s_mov_b32 exec_hi, 0xffff0000
    ds_write_b128 v6, a[248:251]
    s_mov_b64 exec, -1
    s_waitcnt lgkmcnt(0)
    s_barrier
    s_mov_b32 s32, s8
    s_mov_b32 s33, s9
    s_add_u32 s36, s27, 67108864
    s_add_u32 s37, s54, 0
    s_waitcnt vmcnt(5)
    s_mov_b32 m0, s37
    s_add_u32 s37, s37, 4096
    buffer_load_dwordx4 v4, s[32:35], s36 offen nt lds
    s_add_u32 s36, s36, 4096
    s_mov_b32 m0, s37
    s_add_u32 s37, s37, 4096
    buffer_load_dwordx4 v4, s[32:35], s36 offen nt lds
    s_add_u32 s36, s36, 4096
    s_mov_b32 m0, s37
    s_add_u32 s37, s37, 4096
    buffer_load_dwordx4 v4, s[32:35], s36 offen nt lds
    s_add_u32 s36, s36, 4096
    s_mov_b32 m0, s37
    s_add_u32 s37, s37, 4096
    buffer_load_dwordx4 v4, s[32:35], s36 offen nt lds
    s_add_u32 s36, s36, 4096
    s_mov_b32 s64, 44160
    s_call_b64 s[30:31], L_b0
    s_mov_b32 m0, s37
    s_add_u32 s37, s37, 4096
    buffer_load_dwordx4 v4, s[32:35], s36 offen nt lds
    s_add_u32 s36, s36, 4096
    s_mov_b32 m0, s37
    s_add_u32 s37, s37, 4096
    buffer_load_dwordx4 v4, s[32:35], s36 offen nt lds
    s_add_u32 s36, s36, 4096
    s_mov_b32 m0, s37
    s_add_u32 s37, s37, 4096
    buffer_load_dwordx4 v4, s[32:35], s36 offen nt lds
    s_add_u32 s36, s36, 4096
    s_mov_b32 s38, 0
    s_call_b64 s[30:31], L_ar0
    s_waitcnt vmcnt(5)
    s_mov_b32 m0, s37
    s_add_u32 s37, s37, 4096
    buffer_load_dwordx4 v4, s[32:35], s36 offen nt lds
    s_add_u32 s36, s36, 4096
    s_waitcnt vmcnt(8)
    s_barrier
    s_mov_b32 m0, s37
    s_add_u32 s37, s37, 4096
    buffer_load_dwordx4 v4, s[32:35], s36 offen nt lds
    s_add_u32 s36, s36, 4096
    s_mov_b32 m0, s37
    s_add_u32 s37, s37, 4096
    buffer_load_dwordx4 v4, s[32:35], s36 offen nt lds
    s_add_u32 s36, s36, 4096
    v_xor_b32 v52, 32, v5
    ds_read_b64_tr_b16 a[0:1], v5 offset:0
    ds_read_b64_tr_b16 a[2:3], v5 offset:4096
    ds_read_b64_tr_b16 a[4:5], v52 offset:0
    ds_read_b64_tr_b16 a[6:7], v52 offset:4096
    ds_read_b64_tr_b16 a[8:9], v5 offset:8192
    ds_read_b64_tr_b16 a[10:11], v5 offset:12288
    ds_read_b64_tr_b16 a[12:13], v52 offset:8192
    ds_read_b64_tr_b16 a[14:15], v52 offset:12288
    ds_read_b64_tr_b16 a[16:17], v5 offset:16384
    ds_read_b64_tr_b16 a[18:19], v5 offset:20480
    ds_read_b64_tr_b16 a[20:21], v52 offset:16384
    ds_read_b64_tr_b16 a[22:23], v52 offset:20480
    ds_read_b64_tr_b16 a[24:25], v5 offset:24576
    ds_read_b64_tr_b16 a[26:27], v5 offset:28672
    ds_read_b64_tr_b16 a[28:29], v52 offset:24576
    ds_read_b64_tr_b16 a[30:31], v52 offset:28672
    ds_read_b64_tr_b16 a[32:33], v5 offset:32768
    ds_read_b64_tr_b16 a[34:35], v5 offset:36864
    ds_read_b64_tr_b16 a[36:37], v52 offset:32768
    ds_read_b64_tr_b16 a[38:39], v52 offset:36864
    ds_read_b64_tr_b16 a[40:41], v5 offset:40960
    ds_read_b64_tr_b16 a[42:43], v5 offset:45056
    ds_read_b64_tr_b16 a[44:45], v52 offset:40960
    ds_read_b64_tr_b16 a[46:47], v52 offset:45056
    ds_read_b64_tr_b16 a[48:49], v5 offset:49152
    ds_read_b64_tr_b16 a[50:51], v5 offset:53248
    ds_read_b64_tr_b16 a[52:53], v52 offset:49152
    ds_read_b64_tr_b16 a[54:55], v52 offset:53248
    ds_read_b64_tr_b16 a[56:57], v5 offset:57344
    ds_read_b64_tr_b16 a[58:59], v5 offset:61440
    ds_read_b64_tr_b16 a[60:61], v52 offset:57344
    ds_read_b64_tr_b16 a[62:63], v52 offset:61440
    v_xor_b32 v53, 32, v7
    v_xor_b32 v54, 128, v7
    v_xor_b32 v55, 160, v7
    ds_read_b64_tr_b16 a[64:65], v7
    ds_read_b64_tr_b16 a[66:67], v54 offset:1024
    ds_read_b64_tr_b16 a[68:69], v53
    ds_read_b64_tr_b16 a[70:71], v55 offset:1024
    s_mov_b32 m0, s37
    s_add_u32 s37, s37, 4096
    buffer_load_dwordx4 v4, s[32:35], s36 offen nt lds
    s_add_u32 s36, s36, 4096
    s_mov_b32 m0, s37
    s_add_u32 s37, s37, 4096
    buffer_load_dwordx4 v4, s[32:35], s36 offen nt lds
    s_add_u32 s36, s36, 4096
    s_mov_b32 m0, s37
    s_add_u32 s37, s37, 4096
    buffer_load_dwordx4 v4, s[32:35], s36 offen nt lds
    s_add_u32 s36, s36, 4096
    s_mov_b32 s64, 154752
    s_call_b64 s[30:31], L_b0
    s_waitcnt vmcnt(5)
    s_mov_b32 m0, s37
    s_add_u32 s37, s37, 4096
    buffer_load_dwordx4 v4, s[32:35], s36 offen nt lds
    s_add_u32 s36, s36, 4096
    s_waitcnt vmcnt(5)
    s_mov_b32 m0, s37
    s_add_u32 s37, s37, 4096
    buffer_load_dwordx4 v4, s[32:35], s36 offen nt lds
    s_add_u32 s36, s36, 4096
    s_waitcnt vmcnt(5)
    s_mov_b32 m0, s37
    s_add_u32 s37, s37, 4096
    buffer_load_dwordx4 v4, s[32:35], s36 offen nt lds
    s_add_u32 s36, s36, 4096
    s_waitcnt vmcnt(5)
    s_mov_b32 m0, s37
    s_add_u32 s37, s37, 4096
    buffer_load_dwordx4 v4, s[32:35], s36 offen nt lds
    s_add_u32 s36, s36, 4096
    s_waitcnt vmcnt(5)
    s_mov_b32 m0, s37
    s_add_u32 s37, s37, 4096
    buffer_load_dwordx4 v4, s[32:35], s36 offen nt lds
    s_add_u32 s36, s36, 4096
    s_waitcnt lgkmcnt(0)
    s_barrier
    s_mov_b32 s32, s12
    s_mov_b32 s33, s13
    s_add_u32 s36, s27, 67108864
    s_add_u32 s37, s54, 73728
    s_waitcnt vmcnt(5)
    s_mov_b32 m0, s37
    s_add_u32 s37, s37, 4096
    buffer_load_dwordx4 v4, s[32:35], s36 offen nt lds
    s_add_u32 s36, s36, 4096
    s_waitcnt vmcnt(5)
    s_mov_b32 m0, s37
    s_add_u32 s37, s37, 4096
    buffer_load_dwordx4 v4, s[32:35], s36 offen nt lds
    s_add_u32 s36, s36, 4096
    s_waitcnt vmcnt(5)
    s_mov_b32 m0, s37
    s_add_u32 s37, s37, 4096
    buffer_load_dwordx4 v4, s[32:35], s36 offen nt lds
    s_add_u32 s36, s36, 4096
    s_waitcnt vmcnt(5)
    s_mov_b32 m0, s37
    s_add_u32 s37, s37, 4096
    buffer_load_dwordx4 v4, s[32:35], s36 offen nt lds
    s_add_u32 s36, s36, 4096
    s_waitcnt vmcnt(5)
    s_mov_b32 m0, s37
    s_add_u32 s37, s37, 4096
    buffer_load_dwordx4 v4, s[32:35], s36 offen nt lds
    s_add_u32 s36, s36, 4096
    s_waitcnt vmcnt(5)
    s_mov_b32 m0, s37
    s_add_u32 s37, s37, 4096
    buffer_load_dwordx4 v4, s[32:35], s36 offen nt lds
    s_add_u32 s36, s36, 4096
    s_waitcnt vmcnt(5)
    s_mov_b32 m0, s37
    s_add_u32 s37, s37, 4096
    buffer_load_dwordx4 v4, s[32:35], s36 offen nt lds
    s_add_u32 s36, s36, 4096
    s_waitcnt vmcnt(5)
    s_mov_b32 m0, s37
    s_add_u32 s37, s37, 4096
    buffer_load_dwordx4 v4, s[32:35], s36 offen nt lds
    s_add_u32 s36, s36, 4096
    s_mov_b32 s65, 9216
    buffer_load_dwordx4 v[44:47], v13, s[16:19], s65 offen sc1
    s_waitcnt vmcnt(5)
    s_mov_b32 m0, s37
    s_add_u32 s37, s37, 4096
    buffer_load_dwordx4 v4, s[32:35], s36 offen nt lds
    s_add_u32 s36, s36, 4096
    s_waitcnt vmcnt(5)
    s_mov_b32 m0, s37
    s_add_u32 s37, s37, 4096
    buffer_load_dwordx4 v4, s[32:35], s36 offen nt lds
    s_add_u32 s36, s36, 4096
    s_waitcnt vmcnt(5)
    s_mov_b32 m0, s37
    s_add_u32 s37, s37, 4096
    buffer_load_dwordx4 v4, s[32:35], s36 offen nt lds
    s_add_u32 s36, s36, 4096
    s_waitcnt vmcnt(5)
    s_mov_b32 m0, s37
    s_add_u32 s37, s37, 4096
    buffer_load_dwordx4 v4, s[32:35], s36 offen nt lds
    s_add_u32 s36, s36, 4096
    s_waitcnt vmcnt(5)
    s_mov_b32 m0, s37
    s_add_u32 s37, s37, 4096
    buffer_load_dwordx4 v4, s[32:35], s36 offen nt lds
    s_add_u32 s36, s36, 4096
    s_waitcnt vmcnt(14)
    s_waitcnt vmcnt(5)
    s_mov_b32 m0, s37
    s_add_u32 s37, s37, 4096
    buffer_load_dwordx4 v4, s[32:35], s36 offen nt lds
    s_add_u32 s36, s36, 4096
    s_mov_b32 m0, s37
    s_add_u32 s37, s37, 4096
    buffer_load_dwordx4 v4, s[32:35], s36 offen nt lds
    s_add_u32 s36, s36, 4096
    s_mov_b32 m0, s37
    s_add_u32 s37, s37, 4096
    buffer_load_dwordx4 v4, s[32:35], s36 offen nt lds
    s_add_u32 s36, s36, 4096
    s_mov_b32 s38, 0
    s_call_b64 s[30:31], L_a1
    s_mov_b32 m0, s37
    s_add_u32 s37, s37, 4096
    buffer_load_dwordx4 v4, s[32:35], s36 offen nt lds
    s_add_u32 s36, s36, 4096
    s_mov_b32 m0, s37
    s_add_u32 s37, s37, 4096
    buffer_load_dwordx4 v4, s[32:35], s36 offen nt lds
    s_add_u32 s36, s36, 4096
    v_xor_b32 v53, 64, v2
    v_xor_b32 v54, 128, v2
    v_xor_b32 v55, 192, v2
    ds_read_b128 v[128:131], v2 offset:0
    ds_read_b128 v[132:135], v53 offset:0
    ds_read_b128 v[136:139], v54 offset:0
    ds_read_b128 v[140:143], v55 offset:0
    ds_read_b128 v[144:147], v2 offset:4096
    ds_read_b128 v[148:151], v53 offset:4096
    ds_read_b128 v[152:155], v54 offset:4096
    ds_read_b128 v[156:159], v55 offset:4096
    ds_read_b128 v[160:163], v2 offset:8192
    ds_read_b128 v[164:167], v53 offset:8192
    ds_read_b128 v[168:171], v54 offset:8192
    ds_read_b128 v[172:175], v55 offset:8192
    ds_read_b128 v[176:179], v2 offset:12288
    ds_read_b128 v[180:183], v53 offset:12288
    ds_read_b128 v[184:187], v54 offset:12288
    ds_read_b128 v[188:191], v55 offset:12288
    v_xor_b32 v53, 64, v3
    v_xor_b32 v54, 128, v3
    v_xor_b32 v55, 192, v3
    s_mov_b64 exec, s[58:59]
    ds_read_b128 a[216:219], v3 offset:0
    ds_read_b128 a[220:223], v53 offset:0
    ds_read_b128 a[224:227], v54 offset:0
    ds_read_b128 a[228:231], v55 offset:0
    s_mov_b64 exec, -1
    s_mov_b32 exec_lo, 0xffff
    s_mov_b32 exec_hi, 0x0
    ds_write_b128 v6, a[252:255]
    s_mov_b64 exec, -1
    s_waitcnt lgkmcnt(0)
    s_barrier
    s_mov_b32 s32, s8
    s_mov_b32 s33, s9
    s_add_u32 s36, s27, 83886080
    s_add_u32 s37, s54, 0
    s_waitcnt vmcnt(6)
    s_mov_b32 m0, s37
    s_add_u32 s37, s37, 4096
    buffer_load_dwordx4 v4, s[32:35], s36 offen nt lds
    s_add_u32 s36, s36, 4096
    s_mov_b32 m0, s37
    s_add_u32 s37, s37, 4096
    buffer_load_dwordx4 v4, s[32:35], s36 offen nt lds
    s_add_u32 s36, s36, 4096
    s_mov_b32 m0, s37
    s_add_u32 s37, s37, 4096
    buffer_load_dwordx4 v4, s[32:35], s36 offen nt lds
    s_add_u32 s36, s36, 4096
    s_mov_b32 m0, s37
    s_add_u32 s37, s37, 4096
    buffer_load_dwordx4 v4, s[32:35], s36 offen nt lds
    s_add_u32 s36, s36, 4096
    s_mov_b32 s64, 81024
    s_call_b64 s[30:31], L_b1
    s_mov_b32 m0, s37
    s_add_u32 s37, s37, 4096
    buffer_load_dwordx4 v4, s[32:35], s36 offen nt lds
    s_add_u32 s36, s36, 4096
    s_mov_b32 m0, s37
    s_add_u32 s37, s37, 4096
    buffer_load_dwordx4 v4, s[32:35], s36 offen nt lds
    s_add_u32 s36, s36, 4096
    s_mov_b32 m0, s37
    s_add_u32 s37, s37, 4096
    buffer_load_dwordx4 v4, s[32:35], s36 offen nt lds
    s_add_u32 s36, s36, 4096
    s_mov_b32 s38, 0
    s_call_b64 s[30:31], L_ar1
    s_waitcnt vmcnt(6)
    s_mov_b32 m0, s37
    s_add_u32 s37, s37, 4096
    buffer_load_dwordx4 v4, s[32:35], s36 offen nt lds
    s_add_u32 s36, s36, 4096
    s_waitcnt vmcnt(8)
    s_barrier
    s_mov_b32 m0, s37
    s_add_u32 s37, s37, 4096
    buffer_load_dwordx4 v4, s[32:35], s36 offen nt lds
    s_add_u32 s36, s36, 4096
    s_mov_b32 m0, s37
    s_add_u32 s37, s37, 4096
    buffer_load_dwordx4 v4, s[32:35], s36 offen nt lds
    s_add_u32 s36, s36, 4096
    v_xor_b32 v52, 32, v5
    ds_read_b64_tr_b16 a[72:73], v5 offset:0
    ds_read_b64_tr_b16 a[74:75], v5 offset:4096
    ds_read_b64_tr_b16 a[76:77], v52 offset:0
    ds_read_b64_tr_b16 a[78:79], v52 offset:4096
    ds_read_b64_tr_b16 a[80:81], v5 offset:8192
    ds_read_b64_tr_b16 a[82:83], v5 offset:12288
    ds_read_b64_tr_b16 a[84:85], v52 offset:8192
    ds_read_b64_tr_b16 a[86:87], v52 offset:12288
    ds_read_b64_tr_b16 a[88:89], v5 offset:16384
    ds_read_b64_tr_b16 a[90:91], v5 offset:20480
    ds_read_b64_tr_b16 a[92:93], v52 offset:16384
    ds_read_b64_tr_b16 a[94:95], v52 offset:20480
    ds_read_b64_tr_b16 a[96:97], v5 offset:24576
    ds_read_b64_tr_b16 a[98:99], v5 offset:28672
    ds_read_b64_tr_b16 a[100:101], v52 offset:24576
    ds_read_b64_tr_b16 a[102:103], v52 offset:28672
    ds_read_b64_tr_b16 a[104:105], v5 offset:32768
    ds_read_b64_tr_b16 a[106:107], v5 offset:36864
    ds_read_b64_tr_b16 a[108:109], v52 offset:32768
    ds_read_b64_tr_b16 a[110:111], v52 offset:36864
    ds_read_b64_tr_b16 a[112:113], v5 offset:40960
    ds_read_b64_tr_b16 a[114:115], v5 offset:45056
    ds_read_b64_tr_b16 a[116:117], v52 offset:40960
    ds_read_b64_tr_b16 a[118:119], v52 offset:45056
    ds_read_b64_tr_b16 a[120:121], v5 offset:49152
    ds_read_b64_tr_b16 a[122:123], v5 offset:53248
    ds_read_b64_tr_b16 a[124:125], v52 offset:49152
    ds_read_b64_tr_b16 a[126:127], v52 offset:53248
    ds_read_b64_tr_b16 a[128:129], v5 offset:57344
    ds_read_b64_tr_b16 a[130:131], v5 offset:61440
    ds_read_b64_tr_b16 a[132:133], v52 offset:57344
    ds_read_b64_tr_b16 a[134:135], v52 offset:61440
    v_xor_b32 v53, 32, v7
    v_xor_b32 v54, 128, v7
    v_xor_b32 v55, 160, v7
    ds_read_b64_tr_b16 a[136:137], v7
    ds_read_b64_tr_b16 a[138:139], v54 offset:1024
    ds_read_b64_tr_b16 a[140:141], v53
    ds_read_b64_tr_b16 a[142:143], v55 offset:1024
    s_mov_b32 m0, s37
    s_add_u32 s37, s37, 4096
    buffer_load_dwordx4 v4, s[32:35], s36 offen nt lds
    s_add_u32 s36, s36, 4096
    s_mov_b32 m0, s37
    s_add_u32 s37, s37, 4096
    buffer_load_dwordx4 v4, s[32:35], s36 offen nt lds
    s_add_u32 s36, s36, 4096
    s_mov_b32 m0, s37
    s_add_u32 s37, s37, 4096
    buffer_load_dwordx4 v4, s[32:35], s36 offen nt lds
    s_add_u32 s36, s36, 4096
    s_mov_b32 s64, 191616
    s_call_b64 s[30:31], L_b1
    s_waitcnt vmcnt(6)
    s_mov_b32 m0, s37
    s_add_u32 s37, s37, 4096
    buffer_load_dwordx4 v4, s[32:35], s36 offen nt lds
    s_add_u32 s36, s36, 4096
    s_waitcnt vmcnt(6)
    s_mov_b32 m0, s37
    s_add_u32 s37, s37, 4096
    buffer_load_dwordx4 v4, s[32:35], s36 offen nt lds
    s_add_u32 s36, s36, 4096
    s_waitcnt vmcnt(6)
    s_mov_b32 m0, s37
    s_add_u32 s37, s37, 4096
    buffer_load_dwordx4 v4, s[32:35], s36 offen nt lds
    s_add_u32 s36, s36, 4096
    s_waitcnt vmcnt(6)
    s_mov_b32 m0, s37
    s_add_u32 s37, s37, 4096
    buffer_load_dwordx4 v4, s[32:35], s36 offen nt lds
    s_add_u32 s36, s36, 4096
    s_waitcnt vmcnt(6)
    s_mov_b32 m0, s37
    s_add_u32 s37, s37, 4096
    buffer_load_dwordx4 v4, s[32:35], s36 offen nt lds
    s_add_u32 s36, s36, 4096
    s_waitcnt lgkmcnt(0)
    s_barrier
    s_mov_b32 s32, s12
    s_mov_b32 s33, s13
    s_add_u32 s36, s27, 83886080
    s_add_u32 s37, s54, 73728
    s_waitcnt vmcnt(6)
    s_mov_b32 m0, s37
    s_add_u32 s37, s37, 4096
    buffer_load_dwordx4 v4, s[32:35], s36 offen nt lds
    s_add_u32 s36, s36, 4096
    s_waitcnt vmcnt(6)
    s_mov_b32 m0, s37
    s_add_u32 s37, s37, 4096
    buffer_load_dwordx4 v4, s[32:35], s36 offen nt lds
    s_add_u32 s36, s36, 4096
    s_waitcnt vmcnt(6)
    s_mov_b32 m0, s37
    s_add_u32 s37, s37, 4096
    buffer_load_dwordx4 v4, s[32:35], s36 offen nt lds
    s_add_u32 s36, s36, 4096
    s_waitcnt vmcnt(6)
    s_mov_b32 m0, s37
    s_add_u32 s37, s37, 4096
    buffer_load_dwordx4 v4, s[32:35], s36 offen nt lds
    s_add_u32 s36, s36, 4096
    s_waitcnt vmcnt(6)
    s_mov_b32 m0, s37
    s_add_u32 s37, s37, 4096
    buffer_load_dwordx4 v4, s[32:35], s36 offen nt lds
    s_add_u32 s36, s36, 4096
    s_waitcnt vmcnt(6)
    s_mov_b32 m0, s37
    s_add_u32 s37, s37, 4096
    buffer_load_dwordx4 v4, s[32:35], s36 offen nt lds
    s_add_u32 s36, s36, 4096
    s_waitcnt vmcnt(6)
    s_mov_b32 m0, s37
    s_add_u32 s37, s37, 4096
    buffer_load_dwordx4 v4, s[32:35], s36 offen nt lds
    s_add_u32 s36, s36, 4096
    s_waitcnt vmcnt(6)
    s_mov_b32 m0, s37
    s_add_u32 s37, s37, 4096
    buffer_load_dwordx4 v4, s[32:35], s36 offen nt lds
    s_add_u32 s36, s36, 4096
    s_mov_b32 s65, 10240
    buffer_load_dwordx4 v[44:47], v13, s[16:19], s65 offen sc1
    s_waitcnt vmcnt(6)
    s_mov_b32 m0, s37
    s_add_u32 s37, s37, 4096
    buffer_load_dwordx4 v4, s[32:35], s36 offen nt lds
    s_add_u32 s36, s36, 4096
    s_waitcnt vmcnt(6)
    s_mov_b32 m0, s37
    s_add_u32 s37, s37, 4096
    buffer_load_dwordx4 v4, s[32:35], s36 offen nt lds
    s_add_u32 s36, s36, 4096
    s_waitcnt vmcnt(6)
    s_mov_b32 m0, s37
    s_add_u32 s37, s37, 4096
    buffer_load_dwordx4 v4, s[32:35], s36 offen nt lds
    s_add_u32 s36, s36, 4096
    s_waitcnt vmcnt(6)
    s_mov_b32 m0, s37
    s_add_u32 s37, s37, 4096
    buffer_load_dwordx4 v4, s[32:35], s36 offen nt lds
    s_add_u32 s36, s36, 4096
    s_waitcnt vmcnt(6)
    s_mov_b32 m0, s37
    s_add_u32 s37, s37, 4096
    buffer_load_dwordx4 v4, s[32:35], s36 offen nt lds
    s_add_u32 s36, s36, 4096
    s_waitcnt vmcnt(14)
    s_waitcnt vmcnt(5)
    s_mov_b32 m0, s37
    s_add_u32 s37, s37, 4096
    buffer_load_dwordx4 v4, s[32:35], s36 offen nt lds
    s_add_u32 s36, s36, 4096
    s_mov_b32 m0, s37
    s_add_u32 s37, s37, 4096
    buffer_load_dwordx4 v4, s[32:35], s36 offen nt lds
    s_add_u32 s36, s36, 4096
    s_mov_b32 m0, s37
    s_add_u32 s37, s37, 4096
    buffer_load_dwordx4 v4, s[32:35], s36 offen nt lds
    s_add_u32 s36, s36, 4096
    s_mov_b32 s38, 0
    s_call_b64 s[30:31], L_a2
    s_mov_b32 m0, s37
    s_add_u32 s37, s37, 4096
    buffer_load_dwordx4 v4, s[32:35], s36 offen nt lds
    s_add_u32 s36, s36, 4096
    s_mov_b32 m0, s37
    s_add_u32 s37, s37, 4096
    buffer_load_dwordx4 v4, s[32:35], s36 offen nt lds
    s_add_u32 s36, s36, 4096
    v_xor_b32 v53, 64, v2
    v_xor_b32 v54, 128, v2
    v_xor_b32 v55, 192, v2
    ds_read_b128 v[192:195], v2 offset:0
    ds_read_b128 v[196:199], v53 offset:0
    ds_read_b128 v[200:203], v54 offset:0
    ds_read_b128 v[204:207], v55 offset:0
    ds_read_b128 v[208:211], v2 offset:4096
    ds_read_b128 v[212:215], v53 offset:4096
    ds_read_b128 v[216:219], v54 offset:4096
    ds_read_b128 v[220:223], v55 offset:4096
    ds_read_b128 v[224:227], v2 offset:8192
    ds_read_b128 v[228:231], v53 offset:8192
    ds_read_b128 v[232:235], v54 offset:8192
    ds_read_b128 v[236:239], v55 offset:8192
    ds_read_b128 v[240:243], v2 offset:12288
    ds_read_b128 v[244:247], v53 offset:12288
    ds_read_b128 v[248:251], v54 offset:12288
    ds_read_b128 v[252:255], v55 offset:12288
    v_xor_b32 v53, 64, v3
    v_xor_b32 v54, 128, v3
    v_xor_b32 v55, 192, v3
    s_mov_b64 exec, s[56:57]
    ds_read_b128 a[232:235], v3 offset:0
    ds_read_b128 a[236:239], v53 offset:0
    ds_read_b128 a[240:243], v54 offset:0
    ds_read_b128 a[244:247], v55 offset:0
    s_mov_b64 exec, -1
    s_mov_b32 exec_lo, 0xffff0000
    s_mov_b32 exec_hi, 0x0
    ds_write_b128 v6, a[252:255]
    s_mov_b64 exec, -1
    s_waitcnt lgkmcnt(0)
    s_barrier
    s_mov_b32 s32, s8
    s_mov_b32 s33, s9
    s_add_u32 s36, s27, 100663296
    s_add_u32 s37, s54, 0
    s_waitcnt vmcnt(6)
    s_mov_b32 m0, s37
    s_add_u32 s37, s37, 4096
    buffer_load_dwordx4 v4, s[32:35], s36 offen nt lds
    s_add_u32 s36, s36, 4096
    s_mov_b32 m0, s37
    s_add_u32 s37, s37, 4096
    buffer_load_dwordx4 v4, s[32:35], s36 offen nt lds
    s_add_u32 s36, s36, 4096
    s_mov_b32 m0, s37
    s_add_u32 s37, s37, 4096
    buffer_load_dwordx4 v4, s[32:35], s36 offen nt lds
    s_add_u32 s36, s36, 4096
    s_mov_b32 m0, s37
    s_add_u32 s37, s37, 4096
    buffer_load_dwordx4 v4, s[32:35], s36 offen nt lds
    s_add_u32 s36, s36, 4096
    s_mov_b32 s64, 117888
    s_call_b64 s[30:31], L_b2
    s_mov_b32 m0, s37
    s_add_u32 s37, s37, 4096
    buffer_load_dwordx4 v4, s[32:35], s36 offen nt lds
    s_add_u32 s36, s36, 4096
    s_mov_b32 m0, s37
    s_add_u32 s37, s37, 4096
    buffer_load_dwordx4 v4, s[32:35], s36 offen nt lds
    s_add_u32 s36, s36, 4096
    s_mov_b32 m0, s37
    s_add_u32 s37, s37, 4096
    buffer_load_dwordx4 v4, s[32:35], s36 offen nt lds
    s_add_u32 s36, s36, 4096
    s_mov_b32 s38, 0
    s_call_b64 s[30:31], L_ar2
    s_waitcnt vmcnt(6)
    s_mov_b32 m0, s37
    s_add_u32 s37, s37, 4096
    buffer_load_dwordx4 v4, s[32:35], s36 offen nt lds
    s_add_u32 s36, s36, 4096
    s_waitcnt vmcnt(8)
    s_barrier
    s_mov_b32 m0, s37
    s_add_u32 s37, s37, 4096
    buffer_load_dwordx4 v4, s[32:35], s36 offen nt lds
    s_add_u32 s36, s36, 4096
    s_mov_b32 m0, s37
    s_add_u32 s37, s37, 4096
    buffer_load_dwordx4 v4, s[32:35], s36 offen nt lds
    s_add_u32 s36, s36, 4096
    v_xor_b32 v52, 32, v5
    ds_read_b64_tr_b16 a[144:145], v5 offset:0
    ds_read_b64_tr_b16 a[146:147], v5 offset:4096
    ds_read_b64_tr_b16 a[148:149], v52 offset:0
    ds_read_b64_tr_b16 a[150:151], v52 offset:4096
    ds_read_b64_tr_b16 a[152:153], v5 offset:8192
    ds_read_b64_tr_b16 a[154:155], v5 offset:12288
    ds_read_b64_tr_b16 a[156:157], v52 offset:8192
    ds_read_b64_tr_b16 a[158:159], v52 offset:12288
    ds_read_b64_tr_b16 a[160:161], v5 offset:16384
    ds_read_b64_tr_b16 a[162:163], v5 offset:20480
    ds_read_b64_tr_b16 a[164:165], v52 offset:16384
    ds_read_b64_tr_b16 a[166:167], v52 offset:20480
    ds_read_b64_tr_b16 a[168:169], v5 offset:24576
    ds_read_b64_tr_b16 a[170:171], v5 offset:28672
    ds_read_b64_tr_b16 a[172:173], v52 offset:24576
    ds_read_b64_tr_b16 a[174:175], v52 offset:28672
    ds_read_b64_tr_b16 a[176:177], v5 offset:32768
    ds_read_b64_tr_b16 a[178:179], v5 offset:36864
    ds_read_b64_tr_b16 a[180:181], v52 offset:32768
    ds_read_b64_tr_b16 a[182:183], v52 offset:36864
    ds_read_b64_tr_b16 a[184:185], v5 offset:40960
    ds_read_b64_tr_b16 a[186:187], v5 offset:45056
    ds_read_b64_tr_b16 a[188:189], v52 offset:40960
    ds_read_b64_tr_b16 a[190:191], v52 offset:45056
    ds_read_b64_tr_b16 a[192:193], v5 offset:49152
    ds_read_b64_tr_b16 a[194:195], v5 offset:53248
    ds_read_b64_tr_b16 a[196:197], v52 offset:49152
    ds_read_b64_tr_b16 a[198:199], v52 offset:53248
    ds_read_b64_tr_b16 a[200:201], v5 offset:57344
    ds_read_b64_tr_b16 a[202:203], v5 offset:61440
    ds_read_b64_tr_b16 a[204:205], v52 offset:57344
    ds_read_b64_tr_b16 a[206:207], v52 offset:61440
    v_xor_b32 v53, 32, v7
    v_xor_b32 v54, 128, v7
    v_xor_b32 v55, 160, v7
    ds_read_b64_tr_b16 a[208:209], v7
    ds_read_b64_tr_b16 a[210:211], v54 offset:1024
    ds_read_b64_tr_b16 a[212:213], v53
    ds_read_b64_tr_b16 a[214:215], v55 offset:1024
    s_mov_b32 m0, s37
    s_add_u32 s37, s37, 4096
    buffer_load_dwordx4 v4, s[32:35], s36 offen nt lds
    s_add_u32 s36, s36, 4096
    s_mov_b32 m0, s37
    s_add_u32 s37, s37, 4096
    buffer_load_dwordx4 v4, s[32:35], s36 offen nt lds
    s_add_u32 s36, s36, 4096
    s_mov_b32 m0, s37
    s_add_u32 s37, s37, 4096
    buffer_load_dwordx4 v4, s[32:35], s36 offen nt lds
    s_add_u32 s36, s36, 4096
    s_mov_b32 s64, 228480
    s_call_b64 s[30:31], L_b2
    s_waitcnt vmcnt(6)
    s_mov_b32 m0, s37
    s_add_u32 s37, s37, 4096
    buffer_load_dwordx4 v4, s[32:35], s36 offen nt lds
    s_add_u32 s36, s36, 4096
    s_waitcnt vmcnt(6)
    s_mov_b32 m0, s37
    s_add_u32 s37, s37, 4096
    buffer_load_dwordx4 v4, s[32:35], s36 offen nt lds
    s_add_u32 s36, s36, 4096
    s_waitcnt vmcnt(6)
    s_mov_b32 m0, s37
    s_add_u32 s37, s37, 4096
    buffer_load_dwordx4 v4, s[32:35], s36 offen nt lds
    s_add_u32 s36, s36, 4096
    s_waitcnt vmcnt(6)
    s_mov_b32 m0, s37
    s_add_u32 s37, s37, 4096
    buffer_load_dwordx4 v4, s[32:35], s36 offen nt lds
    s_add_u32 s36, s36, 4096
    s_waitcnt vmcnt(6)
    s_mov_b32 m0, s37
    s_add_u32 s37, s37, 4096
    buffer_load_dwordx4 v4, s[32:35], s36 offen nt lds
    s_add_u32 s36, s36, 4096
    s_waitcnt lgkmcnt(0)
    s_barrier
    s_mov_b32 s32, s12
    s_mov_b32 s33, s13
    s_add_u32 s36, s27, 100663296
    s_add_u32 s37, s54, 73728
    s_waitcnt vmcnt(6)
    s_mov_b32 m0, s37
    s_add_u32 s37, s37, 4096
    buffer_load_dwordx4 v4, s[32:35], s36 offen nt lds
    s_add_u32 s36, s36, 4096
    s_waitcnt vmcnt(6)
    s_mov_b32 m0, s37
    s_add_u32 s37, s37, 4096
    buffer_load_dwordx4 v4, s[32:35], s36 offen nt lds
    s_add_u32 s36, s36, 4096
    s_waitcnt vmcnt(6)
    s_mov_b32 m0, s37
    s_add_u32 s37, s37, 4096
    buffer_load_dwordx4 v4, s[32:35], s36 offen nt lds
    s_add_u32 s36, s36, 4096
    s_waitcnt vmcnt(6)
    s_mov_b32 m0, s37
    s_add_u32 s37, s37, 4096
    buffer_load_dwordx4 v4, s[32:35], s36 offen nt lds
    s_add_u32 s36, s36, 4096
    s_waitcnt vmcnt(6)
    s_mov_b32 m0, s37
    s_add_u32 s37, s37, 4096
    buffer_load_dwordx4 v4, s[32:35], s36 offen nt lds
    s_add_u32 s36, s36, 4096
    s_waitcnt vmcnt(6)
    s_mov_b32 m0, s37
    s_add_u32 s37, s37, 4096
    buffer_load_dwordx4 v4, s[32:35], s36 offen nt lds
    s_add_u32 s36, s36, 4096
    s_waitcnt vmcnt(6)
    s_mov_b32 m0, s37
    s_add_u32 s37, s37, 4096
    buffer_load_dwordx4 v4, s[32:35], s36 offen nt lds
    s_add_u32 s36, s36, 4096
    s_waitcnt vmcnt(6)
    s_mov_b32 m0, s37
    s_add_u32 s37, s37, 4096
    buffer_load_dwordx4 v4, s[32:35], s36 offen nt lds
    s_add_u32 s36, s36, 4096
    s_mov_b32 s65, 11264
    buffer_load_dwordx4 v[44:47], v13, s[16:19], s65 offen sc1
    s_waitcnt vmcnt(6)
    s_mov_b32 m0, s37
    s_add_u32 s37, s37, 4096
    buffer_load_dwordx4 v4, s[32:35], s36 offen nt lds
    s_add_u32 s36, s36, 4096
    s_waitcnt vmcnt(6)
    s_mov_b32 m0, s37
    s_add_u32 s37, s37, 4096
    buffer_load_dwordx4 v4, s[32:35], s36 offen nt lds
    s_add_u32 s36, s36, 4096
    s_waitcnt vmcnt(6)
    s_mov_b32 m0, s37
    s_add_u32 s37, s37, 4096
    buffer_load_dwordx4 v4, s[32:35], s36 offen nt lds
    s_add_u32 s36, s36, 4096
    s_waitcnt vmcnt(6)
    s_mov_b32 m0, s37
    s_add_u32 s37, s37, 4096
    buffer_load_dwordx4 v4, s[32:35], s36 offen nt lds
    s_add_u32 s36, s36, 4096
    s_waitcnt vmcnt(6)
    s_mov_b32 m0, s37
    s_add_u32 s37, s37, 4096
    buffer_load_dwordx4 v4, s[32:35], s36 offen nt lds
    s_add_u32 s36, s36, 4096
    s_waitcnt vmcnt(14)
    s_waitcnt vmcnt(5)
    s_mov_b32 m0, s37
    s_add_u32 s37, s37, 4096
    buffer_load_dwordx4 v4, s[32:35], s36 offen nt lds
    s_add_u32 s36, s36, 4096
    s_mov_b32 m0, s37
    s_add_u32 s37, s37, 4096
    buffer_load_dwordx4 v4, s[32:35], s36 offen nt lds
    s_add_u32 s36, s36, 4096
    s_mov_b32 m0, s37
    s_add_u32 s37, s37, 4096
    buffer_load_dwordx4 v4, s[32:35], s36 offen nt lds
    s_add_u32 s36, s36, 4096
    s_mov_b32 s38, 0
    s_call_b64 s[30:31], L_a0
    s_mov_b32 m0, s37
    s_add_u32 s37, s37, 4096
    buffer_load_dwordx4 v4, s[32:35], s36 offen nt lds
    s_add_u32 s36, s36, 4096
    s_mov_b32 m0, s37
    s_add_u32 s37, s37, 4096
    buffer_load_dwordx4 v4, s[32:35], s36 offen nt lds
    s_add_u32 s36, s36, 4096
    v_xor_b32 v53, 64, v2
    v_xor_b32 v54, 128, v2
    v_xor_b32 v55, 192, v2
    ds_read_b128 v[64:67], v2 offset:0
    ds_read_b128 v[68:71], v53 offset:0
    ds_read_b128 v[72:75], v54 offset:0
    ds_read_b128 v[76:79], v55 offset:0
    ds_read_b128 v[80:83], v2 offset:4096
    ds_read_b128 v[84:87], v53 offset:4096
    ds_read_b128 v[88:91], v54 offset:4096
    ds_read_b128 v[92:95], v55 offset:4096
    ds_read_b128 v[96:99], v2 offset:8192
    ds_read_b128 v[100:103], v53 offset:8192
    ds_read_b128 v[104:107], v54 offset:8192
    ds_read_b128 v[108:111], v55 offset:8192
    ds_read_b128 v[112:115], v2 offset:12288
    ds_read_b128 v[116:119], v53 offset:12288
    ds_read_b128 v[120:123], v54 offset:12288
    ds_read_b128 v[124:127], v55 offset:12288
    v_xor_b32 v53, 64, v3
    v_xor_b32 v54, 128, v3
    v_xor_b32 v55, 192, v3
    s_mov_b64 exec, s[56:57]
    ds_read_b128 a[216:219], v3 offset:0
    ds_read_b128 a[220:223], v53 offset:0
    ds_read_b128 a[224:227], v54 offset:0
    ds_read_b128 a[228:231], v55 offset:0
    s_mov_b64 exec, -1
    s_mov_b32 exec_lo, 0x0
    s_mov_b32 exec_hi, 0xffff
    ds_write_b128 v6, a[252:255]
    s_mov_b64 exec, -1
    s_waitcnt lgkmcnt(0)
    s_barrier
    s_mov_b32 s32, s8
    s_mov_b32 s33, s9
    s_add_u32 s36, s27, 117440512
    s_add_u32 s37, s54, 0
    s_waitcnt vmcnt(6)
    s_mov_b32 m0, s37
    s_add_u32 s37, s37, 4096
    buffer_load_dwordx4 v4, s[32:35], s36 offen nt lds
    s_add_u32 s36, s36, 4096
    s_mov_b32 m0, s37
    s_add_u32 s37, s37, 4096
    buffer_load_dwordx4 v4, s[32:35], s36 offen nt lds
    s_add_u32 s36, s36, 4096
    s_mov_b32 m0, s37
    s_add_u32 s37, s37, 4096
    buffer_load_dwordx4 v4, s[32:35], s36 offen nt lds
    s_add_u32 s36, s36, 4096
    s_mov_b32 m0, s37
    s_add_u32 s37, s37, 4096
    buffer_load_dwordx4 v4, s[32:35], s36 offen nt lds
    s_add_u32 s36, s36, 4096
    s_mov_b32 s64, 154752
    s_call_b64 s[30:31], L_b0
    s_mov_b32 m0, s37
    s_add_u32 s37, s37, 4096
    buffer_load_dwordx4 v4, s[32:35], s36 offen nt lds
    s_add_u32 s36, s36, 4096
    s_mov_b32 m0, s37
    s_add_u32 s37, s37, 4096
    buffer_load_dwordx4 v4, s[32:35], s36 offen nt lds
    s_add_u32 s36, s36, 4096
    s_mov_b32 m0, s37
    s_add_u32 s37, s37, 4096
    buffer_load_dwordx4 v4, s[32:35], s36 offen nt lds
    s_add_u32 s36, s36, 4096
    s_mov_b32 s38, 0
    s_call_b64 s[30:31], L_ar0
    s_waitcnt vmcnt(6)
    s_mov_b32 m0, s37
    s_add_u32 s37, s37, 4096
    buffer_load_dwordx4 v4, s[32:35], s36 offen nt lds
    s_add_u32 s36, s36, 4096
    s_waitcnt vmcnt(8)
    s_barrier
    s_mov_b32 m0, s37
    s_add_u32 s37, s37, 4096
    buffer_load_dwordx4 v4, s[32:35], s36 offen nt lds
    s_add_u32 s36, s36, 4096
    s_mov_b32 m0, s37
    s_add_u32 s37, s37, 4096
    buffer_load_dwordx4 v4, s[32:35], s36 offen nt lds
    s_add_u32 s36, s36, 4096
    v_xor_b32 v52, 32, v5
    ds_read_b64_tr_b16 a[0:1], v5 offset:0
    ds_read_b64_tr_b16 a[2:3], v5 offset:4096
    ds_read_b64_tr_b16 a[4:5], v52 offset:0
    ds_read_b64_tr_b16 a[6:7], v52 offset:4096
    ds_read_b64_tr_b16 a[8:9], v5 offset:8192
    ds_read_b64_tr_b16 a[10:11], v5 offset:12288
    ds_read_b64_tr_b16 a[12:13], v52 offset:8192
    ds_read_b64_tr_b16 a[14:15], v52 offset:12288
    ds_read_b64_tr_b16 a[16:17], v5 offset:16384
    ds_read_b64_tr_b16 a[18:19], v5 offset:20480
    ds_read_b64_tr_b16 a[20:21], v52 offset:16384
    ds_read_b64_tr_b16 a[22:23], v52 offset:20480
    ds_read_b64_tr_b16 a[24:25], v5 offset:24576
    ds_read_b64_tr_b16 a[26:27], v5 offset:28672
    ds_read_b64_tr_b16 a[28:29], v52 offset:24576
    ds_read_b64_tr_b16 a[30:31], v52 offset:28672
    ds_read_b64_tr_b16 a[32:33], v5 offset:32768
    ds_read_b64_tr_b16 a[34:35], v5 offset:36864
    ds_read_b64_tr_b16 a[36:37], v52 offset:32768
    ds_read_b64_tr_b16 a[38:39], v52 offset:36864
    ds_read_b64_tr_b16 a[40:41], v5 offset:40960
    ds_read_b64_tr_b16 a[42:43], v5 offset:45056
    ds_read_b64_tr_b16 a[44:45], v52 offset:40960
    ds_read_b64_tr_b16 a[46:47], v52 offset:45056
    ds_read_b64_tr_b16 a[48:49], v5 offset:49152
    ds_read_b64_tr_b16 a[50:51], v5 offset:53248
    ds_read_b64_tr_b16 a[52:53], v52 offset:49152
    ds_read_b64_tr_b16 a[54:55], v52 offset:53248
    ds_read_b64_tr_b16 a[56:57], v5 offset:57344
    ds_read_b64_tr_b16 a[58:59], v5 offset:61440
    ds_read_b64_tr_b16 a[60:61], v52 offset:57344
    ds_read_b64_tr_b16 a[62:63], v52 offset:61440
    v_xor_b32 v53, 32, v7
    v_xor_b32 v54, 128, v7
    v_xor_b32 v55, 160, v7
    ds_read_b64_tr_b16 a[64:65], v7
    ds_read_b64_tr_b16 a[66:67], v54 offset:1024
    ds_read_b64_tr_b16 a[68:69], v53
    ds_read_b64_tr_b16 a[70:71], v55 offset:1024
    s_mov_b32 m0, s37
    s_add_u32 s37, s37, 4096
    buffer_load_dwordx4 v4, s[32:35], s36 offen nt lds
    s_add_u32 s36, s36, 4096
    s_mov_b32 m0, s37
    s_add_u32 s37, s37, 4096
    buffer_load_dwordx4 v4, s[32:35], s36 offen nt lds
    s_add_u32 s36, s36, 4096
    s_mov_b32 m0, s37
    s_add_u32 s37, s37, 4096
    buffer_load_dwordx4 v4, s[32:35], s36 offen nt lds
    s_add_u32 s36, s36, 4096
    s_mov_b32 s64, 265344
    s_call_b64 s[30:31], L_b0
    s_waitcnt vmcnt(6)
    s_mov_b32 m0, s37
    s_add_u32 s37, s37, 4096
    buffer_load_dwordx4 v4, s[32:35], s36 offen nt lds
    s_add_u32 s36, s36, 4096
    s_waitcnt vmcnt(6)
    s_mov_b32 m0, s37
    s_add_u32 s37, s37, 4096
    buffer_load_dwordx4 v4, s[32:35], s36 offen nt lds
    s_add_u32 s36, s36, 4096
    s_waitcnt vmcnt(6)
    s_mov_b32 m0, s37
    s_add_u32 s37, s37, 4096
    buffer_load_dwordx4 v4, s[32:35], s36 offen nt lds
    s_add_u32 s36, s36, 4096
    s_waitcnt vmcnt(6)
    s_mov_b32 m0, s37
    s_add_u32 s37, s37, 4096
    buffer_load_dwordx4 v4, s[32:35], s36 offen nt lds
    s_add_u32 s36, s36, 4096
    s_waitcnt vmcnt(6)
    s_mov_b32 m0, s37
    s_add_u32 s37, s37, 4096
    buffer_load_dwordx4 v4, s[32:35], s36 offen nt lds
    s_add_u32 s36, s36, 4096
    s_waitcnt lgkmcnt(0)
    s_barrier
    s_mov_b32 s32, s12
    s_mov_b32 s33, s13
    s_add_u32 s36, s27, 117440512
    s_add_u32 s37, s54, 73728
    s_waitcnt vmcnt(6)
    s_mov_b32 m0, s37
    s_add_u32 s37, s37, 4096
    buffer_load_dwordx4 v4, s[32:35], s36 offen nt lds
    s_add_u32 s36, s36, 4096
    s_waitcnt vmcnt(6)
    s_mov_b32 m0, s37
    s_add_u32 s37, s37, 4096
    buffer_load_dwordx4 v4, s[32:35], s36 offen nt lds
    s_add_u32 s36, s36, 4096
    s_waitcnt vmcnt(6)
    s_mov_b32 m0, s37
    s_add_u32 s37, s37, 4096
    buffer_load_dwordx4 v4, s[32:35], s36 offen nt lds
    s_add_u32 s36, s36, 4096
    s_waitcnt vmcnt(6)
    s_mov_b32 m0, s37
    s_add_u32 s37, s37, 4096
    buffer_load_dwordx4 v4, s[32:35], s36 offen nt lds
    s_add_u32 s36, s36, 4096
    s_waitcnt vmcnt(6)
    s_mov_b32 m0, s37
    s_add_u32 s37, s37, 4096
    buffer_load_dwordx4 v4, s[32:35], s36 offen nt lds
    s_add_u32 s36, s36, 4096
    s_mov_b32 s65, 12288
    buffer_load_dwordx4 v[44:47], v13, s[16:19], s65 offen sc1
    s_waitcnt vmcnt(6)
    s_mov_b32 m0, s37
    s_add_u32 s37, s37, 4096
    buffer_load_dwordx4 v4, s[32:35], s36 offen nt lds
    s_add_u32 s36, s36, 4096
    s_waitcnt vmcnt(6)
    s_mov_b32 m0, s37
    s_add_u32 s37, s37, 4096
    buffer_load_dwordx4 v4, s[32:35], s36 offen nt lds
    s_add_u32 s36, s36, 4096
    s_waitcnt vmcnt(6)
    s_mov_b32 m0, s37
    s_add_u32 s37, s37, 4096
    buffer_load_dwordx4 v4, s[32:35], s36 offen nt lds
    s_add_u32 s36, s36, 4096
    s_waitcnt vmcnt(6)
    s_mov_b32 m0, s37
    s_add_u32 s37, s37, 4096
    buffer_load_dwordx4 v4, s[32:35], s36 offen nt lds
    s_add_u32 s36, s36, 4096
    s_waitcnt vmcnt(6)
    s_mov_b32 m0, s37
    s_add_u32 s37, s37, 4096
    buffer_load_dwordx4 v4, s[32:35], s36 offen nt lds
    s_add_u32 s36, s36, 4096
    s_waitcnt vmcnt(11)
    s_waitcnt vmcnt(5)
    s_mov_b32 m0, s37
    s_add_u32 s37, s37, 4096
    buffer_load_dwordx4 v4, s[32:35], s36 offen nt lds
    s_add_u32 s36, s36, 4096
    s_mov_b32 m0, s37
    s_add_u32 s37, s37, 4096
    buffer_load_dwordx4 v4, s[32:35], s36 offen nt lds
    s_add_u32 s36, s36, 4096
    s_mov_b32 m0, s37
    s_add_u32 s37, s37, 4096
    buffer_load_dwordx4 v4, s[32:35], s36 offen nt lds
    s_add_u32 s36, s36, 4096
    s_mov_b32 s38, 0
    s_call_b64 s[30:31], L_a1
    s_mov_b32 m0, s37
    s_add_u32 s37, s37, 4096
    buffer_load_dwordx4 v4, s[32:35], s36 offen nt lds
    s_add_u32 s36, s36, 4096
    s_mov_b32 m0, s37
    s_add_u32 s37, s37, 4096
    buffer_load_dwordx4 v4, s[32:35], s36 offen nt lds
    s_add_u32 s36, s36, 4096
    s_mov_b32 m0, s37
    s_add_u32 s37, s37, 4096
    buffer_load_dwordx4 v4, s[32:35], s36 offen nt lds
    s_add_u32 s36, s36, 4096
    s_mov_b32 s64, 191616
    s_call_b64 s[30:31], L_b1
    s_mov_b32 m0, s37
    s_add_u32 s37, s37, 4096
    buffer_load_dwordx4 v4, s[32:35], s36 offen nt lds
    s_add_u32 s36, s36, 4096
    s_mov_b32 m0, s37
    s_add_u32 s37, s37, 4096
    buffer_load_dwordx4 v4, s[32:35], s36 offen nt lds
    s_add_u32 s36, s36, 4096
    v_xor_b32 v53, 64, v2
    v_xor_b32 v54, 128, v2
    v_xor_b32 v55, 192, v2
    ds_read_b128 v[128:131], v2 offset:0
    ds_read_b128 v[132:135], v53 offset:0
    ds_read_b128 v[136:139], v54 offset:0
    ds_read_b128 v[140:143], v55 offset:0
    ds_read_b128 v[144:147], v2 offset:4096
    ds_read_b128 v[148:151], v53 offset:4096
    ds_read_b128 v[152:155], v54 offset:4096
    ds_read_b128 v[156:159], v55 offset:4096
    ds_read_b128 v[160:163], v2 offset:8192
    ds_read_b128 v[164:167], v53 offset:8192
    ds_read_b128 v[168:171], v54 offset:8192
    ds_read_b128 v[172:175], v55 offset:8192
    ds_read_b128 v[176:179], v2 offset:12288
    ds_read_b128 v[180:183], v53 offset:12288
    ds_read_b128 v[184:187], v54 offset:12288
    ds_read_b128 v[188:191], v55 offset:12288
    v_xor_b32 v53, 64, v3
    v_xor_b32 v54, 128, v3
    v_xor_b32 v55, 192, v3
    s_mov_b64 exec, s[58:59]
    ds_read_b128 a[216:219], v3 offset:0
    ds_read_b128 a[220:223], v53 offset:0
    ds_read_b128 a[224:227], v54 offset:0
    ds_read_b128 a[228:231], v55 offset:0
    s_mov_b64 exec, -1
    s_mov_b32 exec_lo, 0x0
    s_mov_b32 exec_hi, 0xffff0000
    ds_write_b128 v6, a[252:255]
    s_mov_b64 exec, -1
    s_waitcnt vmcnt(6)
    s_waitcnt lgkmcnt(0)
    s_barrier
    s_mov_b32 s38, 0
    s_call_b64 s[30:31], L_ar1
    v_xor_b32 v52, 32, v5
    ds_read_b64_tr_b16 a[72:73], v5 offset:0
    ds_read_b64_tr_b16 a[74:75], v5 offset:4096
    ds_read_b64_tr_b16 a[76:77], v52 offset:0
    ds_read_b64_tr_b16 a[78:79], v52 offset:4096
    ds_read_b64_tr_b16 a[80:81], v5 offset:8192
    ds_read_b64_tr_b16 a[82:83], v5 offset:12288
    ds_read_b64_tr_b16 a[84:85], v52 offset:8192
    ds_read_b64_tr_b16 a[86:87], v52 offset:12288
    ds_read_b64_tr_b16 a[88:89], v5 offset:16384
    ds_read_b64_tr_b16 a[90:91], v5 offset:20480
    ds_read_b64_tr_b16 a[92:93], v52 offset:16384
    ds_read_b64_tr_b16 a[94:95], v52 offset:20480
    ds_read_b64_tr_b16 a[96:97], v5 offset:24576
    ds_read_b64_tr_b16 a[98:99], v5 offset:28672
    ds_read_b64_tr_b16 a[100:101], v52 offset:24576
    ds_read_b64_tr_b16 a[102:103], v52 offset:28672
    ds_read_b64_tr_b16 a[104:105], v5 offset:32768
    ds_read_b64_tr_b16 a[106:107], v5 offset:36864
    ds_read_b64_tr_b16 a[108:109], v52 offset:32768
    ds_read_b64_tr_b16 a[110:111], v52 offset:36864
    ds_read_b64_tr_b16 a[112:113], v5 offset:40960
    ds_read_b64_tr_b16 a[114:115], v5 offset:45056
    ds_read_b64_tr_b16 a[116:117], v52 offset:40960
    ds_read_b64_tr_b16 a[118:119], v52 offset:45056
    s_waitcnt vmcnt(0)
    s_barrier
    ds_read_b64_tr_b16 a[120:121], v5 offset:49152
    ds_read_b64_tr_b16 a[122:123], v5 offset:53248
    ds_read_b64_tr_b16 a[124:125], v52 offset:49152
    ds_read_b64_tr_b16 a[126:127], v52 offset:53248
    ds_read_b64_tr_b16 a[128:129], v5 offset:57344
    ds_read_b64_tr_b16 a[130:131], v5 offset:61440
    ds_read_b64_tr_b16 a[132:133], v52 offset:57344
    ds_read_b64_tr_b16 a[134:135], v52 offset:61440
    v_xor_b32 v53, 32, v7
    v_xor_b32 v54, 128, v7
    v_xor_b32 v55, 160, v7
    ds_read_b64_tr_b16 a[136:137], v7
    ds_read_b64_tr_b16 a[138:139], v54 offset:1024
    ds_read_b64_tr_b16 a[140:141], v53
    ds_read_b64_tr_b16 a[142:143], v55 offset:1024
    s_mov_b32 s64, 302208
    s_call_b64 s[30:31], L_b1
    s_mov_b32 s65, 13312
    s_mov_b32 s64, 228480
    s_mov_b32 s38, 1
    s_call_b64 s[30:31], L_aq2
    v_mov_b32 v193, v13
    v_mov_b32 v194, v6
    s_mov_b32 exec_lo, 0
    v_add_u32 v193, 1024, v193
    v_add_u32 v194, 1088, v194
    s_mov_b64 exec, -1
    s_mov_b32 s65, 0
    s_mov_b32 s64, 415744
    s_mov_b32 s70, 415744
    s_call_b64 s[30:31], L_dq
    s_mov_b32 s65, 14336
    s_mov_b32 s64, 339072
    s_mov_b32 s70, 375936
    s_call_b64 s[30:31], L_dq
    s_endpgm
L_aq0:
    s_sub_u32 s66, s66, 1
    s_cbranch_scc1 L_end
    buffer_load_dwordx4 v[44:47], v13, s[16:19], s65 offen sc1
    s_waitcnt vmcnt(0)
L_a0:
    v_max3_u32 v60, v44, v45, v46
    v_max_u32 v60, v60, v47
    v_cmp_eq_u32 vcc, -1, v60
    s_nop 0
    s_cbranch_vccnz L_aq0
    ds_write_b128 v6, v[44:47]
    s_waitcnt lgkmcnt(0)
    s_barrier
L_ar0:
    ds_read_b128 v[16:19], v1 offset:0
    ds_read_b128 v[20:23], v1 offset:64
    ds_read_b128 v[24:27], v1 offset:128
    ds_read_b128 v[28:31], v1 offset:192
    s_waitcnt lgkmcnt(3)
    v_mfma_f32_16x16x32_bf16 v[48:51], a[216:219], v[16:19], 0
    s_waitcnt lgkmcnt(2)
    v_mfma_f32_16x16x32_bf16 v[48:51], a[220:223], v[20:23], v[48:51]
    s_waitcnt lgkmcnt(1)
    v_mfma_f32_16x16x32_bf16 v[48:51], a[224:227], v[24:27], v[48:51]
    s_waitcnt lgkmcnt(0)
    v_mfma_f32_16x16x32_bf16 v[48:51], a[228:231], v[28:31], v[48:51]
    v_mfma_f32_16x16x32_bf16 v[36:39], v[80:83], v[16:19], 0
    v_mfma_f32_16x16x32_bf16 v[36:39], v[84:87], v[20:23], v[36:39]
    v_mfma_f32_16x16x32_bf16 v[36:39], v[88:91], v[24:27], v[36:39]
    v_mfma_f32_16x16x32_bf16 v[36:39], v[92:95], v[28:31], v[36:39]
    v_mfma_f32_16x16x32_bf16 v[40:43], v[96:99], v[16:19], 0
    v_mfma_f32_16x16x32_bf16 v[40:43], v[100:103], v[20:23], v[40:43]
    s_nop 1
    v_cndmask_b32 v48, v63, v48, s[60:61]
    v_cndmask_b32 v49, v63, v49, s[60:61]
    v_mfma_f32_16x16x32_bf16 v[40:43], v[104:107], v[24:27], v[40:43]
    v_cndmask_b32 v50, v63, v50, s[60:61]
    v_cndmask_b32 v51, v63, v51, s[60:61]
    v_mfma_f32_16x16x32_bf16 v[40:43], v[108:111], v[28:31], v[40:43]
    v_max3_f32 v61, v48, v49, v50
    v_mfma_f32_16x16x32_bf16 v[44:47], v[112:115], v[16:19], 0
    v_mfma_f32_16x16x32_bf16 v[44:47], v[116:119], v[20:23], v[44:47]
    v_mfma_f32_16x16x32_bf16 v[44:47], v[120:123], v[24:27], v[44:47]
    v_mfma_f32_16x16x32_bf16 v[44:47], v[124:127], v[28:31], v[44:47]
    v_mfma_f32_16x16x32_bf16 v[32:35], v[64:67], v[16:19], 0
    v_mfma_f32_16x16x32_bf16 v[32:35], v[68:71], v[20:23], v[32:35]
    s_nop 0
    v_mov_b32_dpp v36, v40 quad_perm:[0,1,2,3] row_mask:0xf bank_mask:0x4
    v_mov_b32_dpp v37, v41 quad_perm:[0,1,2,3] row_mask:0xf bank_mask:0x4
    v_mfma_f32_16x16x32_bf16 v[32:35], v[72:75], v[24:27], v[32:35]
    v_mov_b32_dpp v38, v42 quad_perm:[0,1,2,3] row_mask:0xf bank_mask:0x4
    v_mov_b32_dpp v39, v43 quad_perm:[0,1,2,3] row_mask:0xf bank_mask:0x4
    v_mfma_f32_16x16x32_bf16 v[32:35], v[76:79], v[28:31], v[32:35]
    v_mov_b32_dpp v36, v44 quad_perm:[0,1,2,3] row_mask:0xf bank_mask:0x8
    v_mov_b32_dpp v37, v45 quad_perm:[0,1,2,3] row_mask:0xf bank_mask:0x8
    v_mov_b32_dpp v38, v46 quad_perm:[0,1,2,3] row_mask:0xf bank_mask:0x8
    v_mov_b32_dpp v39, v47 quad_perm:[0,1,2,3] row_mask:0xf bank_mask:0x8
    s_nop 3
    v_mov_b32_dpp v36, v32 quad_perm:[0,1,2,3] row_mask:0xf bank_mask:0x1
    v_mov_b32_dpp v37, v33 quad_perm:[0,1,2,3] row_mask:0xf bank_mask:0x1
    v_mov_b32_dpp v38, v34 quad_perm:[0,1,2,3] row_mask:0xf bank_mask:0x1
    v_mov_b32_dpp v39, v35 quad_perm:[0,1,2,3] row_mask:0xf bank_mask:0x1
    v_max3_f32 v60, v36, v37, v51
    v_max3_f32 v61, v61, v38, v39
    v_max_f32 v60, v60, v61
    s_nop 1
    v_max_f32_dpp v60, v60, v60 row_ror:4 row_mask:0xf bank_mask:0xf
    s_nop 1
    v_max_f32_dpp v60, v60, v60 row_ror:8 row_mask:0xf bank_mask:0xf
    v_mov_b32 v61, v60
    s_nop 1
    v_permlane16_swap_b32 v60, v61
    v_max_f32 v60, v60, v61
    v_mov_b32 v61, v60
    s_nop 1
    v_permlane32_swap_b32 v60, v61
    v_max_f32 v60, v60, v61
    v_mul_f32 v60, s29, v60
    v_fma_f32 v36, v36, s29, -v60
    v_fma_f32 v37, v37, s29, -v60
    v_fma_f32 v38, v38, s29, -v60
    v_fma_f32 v39, v39, s29, -v60
    v_fma_f32 v48, v48, s29, -v60
    v_fma_f32 v49, v49, s29, -v60
    v_fma_f32 v50, v50, s29, -v60
    v_fma_f32 v51, v51, s29, -v60
    v_exp_f32 v36, v36
    v_exp_f32 v37, v37
    v_exp_f32 v38, v38
    v_exp_f32 v39, v39
    v_exp_f32 v48, v48
    v_exp_f32 v49, v49
    v_exp_f32 v50, v50
    v_exp_f32 v51, v51
    ds_write_b32 v10, v60
    v_cvt_pk_bf16_f32 v16, v36, v37
    v_cvt_pk_bf16_f32 v17, v38, v39
    v_cvt_pk_bf16_f32 v18, v48, v49
    v_cvt_pk_bf16_f32 v19, v50, v51
    ds_write_b64 v8, v[16:17]
    s_mov_b64 exec, s[60:61]
    ds_write_b64 v9, v[18:19]
    s_mov_b64 exec, -1
    v_add_f32 v61, v36, v37
    v_add_f32 v62, v38, v39
    v_add_f32 v48, v48, v49
    v_add_f32 v50, v50, v51
    v_add_f32 v61, v61, v62
    v_add_f32 v48, v48, v50
    v_add_f32 v61, v61, v48
    s_cmp_eq_u32 s38, 0
    s_waitcnt lgkmcnt(0)
    s_barrier
    s_cbranch_scc1 L_ret
L_b0:
    ds_read_b128 v[16:19], v12 offset:0
    ds_read_b32 v62, v11
    ds_read_b128 v[20:23], v12 offset:256
    ds_read_b128 v[24:27], v56 offset:0
    ds_read_b128 v[28:31], v56 offset:256
    ds_read_b128 v[32:35], v57 offset:0
    ds_read_b128 v[36:39], v57 offset:256
    ds_read_b128 v[40:43], v58 offset:0
    ds_read_b128 v[44:47], v58 offset:256
    v_add_f32_dpp v61, v61, v61 row_ror:4 row_mask:0xf bank_mask:0xf
    s_nop 1
    v_add_f32_dpp v61, v61, v61 row_ror:8 row_mask:0xf bank_mask:0xf
    v_mov_b32 v0, v61
    s_nop 1
    v_permlane16_swap_b32 v61, v0
    v_add_f32 v61, v61, v0
    v_mov_b32 v0, v61
    s_nop 1
    v_permlane32_swap_b32 v61, v0
    v_add_f32 v61, v61, v0
    s_waitcnt lgkmcnt(8)
    v_mfma_f32_16x16x32_bf16 v[48:51], a[0:3], v[16:19], 0
    v_mfma_f32_16x16x32_bf16 v[52:55], a[4:7], v[16:19], 0
    ds_read_b128 v[16:19], v59 offset:0
    s_waitcnt lgkmcnt(7)
    v_mfma_f32_16x16x32_bf16 v[48:51], a[8:11], v[20:23], v[48:51]
    v_mfma_f32_16x16x32_bf16 v[52:55], a[12:15], v[20:23], v[52:55]
    s_waitcnt lgkmcnt(6)
    v_mfma_f32_16x16x32_bf16 v[48:51], a[16:19], v[24:27], v[48:51]
    v_max_f32_dpp v20, v62, v62 row_ror:4 row_mask:0xf bank_mask:0xf
    v_xor_b32 v8, 0x1000, v8
    v_mfma_f32_16x16x32_bf16 v[52:55], a[20:23], v[24:27], v[52:55]
    v_max_f32_dpp v20, v20, v20 row_ror:8 row_mask:0xf bank_mask:0xf
    v_xor_b32 v9, 0x1000, v9
    s_waitcnt lgkmcnt(5)
    v_mfma_f32_16x16x32_bf16 v[48:51], a[24:27], v[28:31], v[48:51]
    v_ceil_f32 v20, v20
    v_xor_b32 v10, 0x1000, v10
    v_mfma_f32_16x16x32_bf16 v[52:55], a[28:31], v[28:31], v[52:55]
    v_sub_f32 v0, v62, v20
    v_sub_f32 v21, v60, v20
    s_waitcnt lgkmcnt(4)
    v_mfma_f32_16x16x32_bf16 v[48:51], a[32:35], v[32:35], v[48:51]
    v_exp_f32 v21, v21
    v_exp_f32 v0, v0
    v_mfma_f32_16x16x32_bf16 v[52:55], a[36:39], v[32:35], v[52:55]
    v_mul_f32 v21, v21, v61
    v_xor_b32 v11, 0x1000, v11
    s_waitcnt lgkmcnt(3)
    v_mfma_f32_16x16x32_bf16 v[48:51], a[40:43], v[36:39], v[48:51]
    v_mfma_f32_16x16x32_bf16 v[52:55], a[44:47], v[36:39], v[52:55]
    s_waitcnt lgkmcnt(2)
    v_mfma_f32_16x16x32_bf16 v[48:51], a[48:51], v[40:43], v[48:51]
    v_xor_b32 v12, 0x1000, v12
    v_mfma_f32_16x16x32_bf16 v[52:55], a[52:55], v[40:43], v[52:55]
    v_xor_b32 v56, 0x1000, v56
    s_waitcnt lgkmcnt(1)
    v_mfma_f32_16x16x32_bf16 v[48:51], a[56:59], v[44:47], v[48:51]
    v_xor_b32 v57, 0x1000, v57
    v_mfma_f32_16x16x32_bf16 v[52:55], a[60:63], v[44:47], v[52:55]
    v_xor_b32 v58, 0x1000, v58
    s_mov_b64 exec, 15
    s_cmp_eq_u32 s4, 0
    s_cbranch_scc1 Lg_5
    buffer_store_dwordx2 v[20:21], v15, s[16:19], s64 offen
Lb_6:
    s_mov_b64 exec, -1
    s_waitcnt lgkmcnt(0)
    v_mfma_f32_16x16x32_bf16 v[48:51], a[64:67], v[16:19], v[48:51]
    v_xor_b32 v59, 0x1000, v59
    v_mfma_f32_16x16x32_bf16 v[52:55], a[68:71], v[16:19], v[52:55]
    s_nop 5
    v_mul_f32 v48, v48, v0
    v_mul_f32 v49, v49, v0
    v_mul_f32 v50, v50, v0
    v_mul_f32 v51, v51, v0
    v_mul_f32 v52, v52, v0
    v_mul_f32 v53, v53, v0
    v_mul_f32 v54, v54, v0
    v_mul_f32 v55, v55, v0
    v_add_f32_dpp v48, v48, v48 row_ror:8 row_mask:0xf bank_mask:0xf
    v_add_f32_dpp v49, v49, v49 row_ror:8 row_mask:0xf bank_mask:0xf
    v_add_f32_dpp v50, v50, v50 row_ror:8 row_mask:0xf bank_mask:0xf
    v_add_f32_dpp v51, v51, v51 row_ror:8 row_mask:0xf bank_mask:0xf
    v_add_f32_dpp v52, v52, v52 row_ror:8 row_mask:0xf bank_mask:0xf
    v_add_f32_dpp v53, v53, v53 row_ror:8 row_mask:0xf bank_mask:0xf
    v_add_f32_dpp v54, v54, v54 row_ror:8 row_mask:0xf bank_mask:0xf
    v_add_f32_dpp v55, v55, v55 row_ror:8 row_mask:0xf bank_mask:0xf
    v_add_f32_dpp v48, v48, v48 row_ror:4 row_mask:0xf bank_mask:0x5
    v_add_f32_dpp v49, v49, v49 row_ror:4 row_mask:0xf bank_mask:0x5
    v_add_f32_dpp v50, v50, v50 row_ror:4 row_mask:0xf bank_mask:0x5
    v_add_f32_dpp v51, v51, v51 row_ror:4 row_mask:0xf bank_mask:0x5
    v_add_f32_dpp v48, v52, v52 row_ror:4 row_mask:0xf bank_mask:0xa
    v_add_f32_dpp v49, v53, v53 row_ror:4 row_mask:0xf bank_mask:0xa
    v_add_f32_dpp v50, v54, v54 row_ror:4 row_mask:0xf bank_mask:0xa
    v_add_f32_dpp v51, v55, v55 row_ror:4 row_mask:0xf bank_mask:0xa
    v_cvt_pk_bf16_f32 v48, v48, v49
    v_cvt_pk_bf16_f32 v49, v50, v51
    s_mov_b64 exec, s[56:57]
    s_cmp_eq_u32 s4, 0
    s_cbranch_scc1 Lg_7
    buffer_store_dwordx2 v[48:49], v14, s[16:19], s64 offen
Lb_8:
    s_mov_b64 exec, -1
    s_setpc_b64 s[30:31]
L_aq1:
    s_sub_u32 s66, s66, 1
    s_cbranch_scc1 L_end
    buffer_load_dwordx4 v[44:47], v13, s[16:19], s65 offen sc1
    s_waitcnt vmcnt(0)
L_a1:
    v_max3_u32 v60, v44, v45, v46
    v_max_u32 v60, v60, v47
    v_cmp_eq_u32 vcc, -1, v60
    s_nop 0
    s_cbranch_vccnz L_aq1
    ds_write_b128 v6, v[44:47]
    s_waitcnt lgkmcnt(0)
    s_barrier
L_ar1:
    ds_read_b128 v[16:19], v1 offset:0
    ds_read_b128 v[20:23], v1 offset:64
    ds_read_b128 v[24:27], v1 offset:128
    ds_read_b128 v[28:31], v1 offset:192
    s_waitcnt lgkmcnt(3)
    v_mfma_f32_16x16x32_bf16 v[48:51], a[216:219], v[16:19], 0
    s_waitcnt lgkmcnt(2)
    v_mfma_f32_16x16x32_bf16 v[48:51], a[220:223], v[20:23], v[48:51]
    s_waitcnt lgkmcnt(1)
    v_mfma_f32_16x16x32_bf16 v[48:51], a[224:227], v[24:27], v[48:51]
    s_waitcnt lgkmcnt(0)
    v_mfma_f32_16x16x32_bf16 v[48:51], a[228:231], v[28:31], v[48:51]
    v_mfma_f32_16x16x32_bf16 v[36:39], v[144:147], v[16:19], 0
    v_mfma_f32_16x16x32_bf16 v[36:39], v[148:151], v[20:23], v[36:39]
    v_mfma_f32_16x16x32_bf16 v[36:39], v[152:155], v[24:27], v[36:39]
    v_mfma_f32_16x16x32_bf16 v[36:39], v[156:159], v[28:31], v[36:39]
    v_mfma_f32_16x16x32_bf16 v[40:43], v[160:163], v[16:19], 0
    v_mfma_f32_16x16x32_bf16 v[40:43], v[164:167], v[20:23], v[40:43]
    s_nop 1
    v_cndmask_b32 v48, v63, v48, s[62:63]
    v_cndmask_b32 v49, v63, v49, s[62:63]
    v_mfma_f32_16x16x32_bf16 v[40:43], v[168:171], v[24:27], v[40:43]
    v_cndmask_b32 v50, v63, v50, s[62:63]
    v_cndmask_b32 v51, v63, v51, s[62:63]
    v_mfma_f32_16x16x32_bf16 v[40:43], v[172:175], v[28:31], v[40:43]
    v_max3_f32 v61, v48, v49, v50
    v_mfma_f32_16x16x32_bf16 v[44:47], v[176:179], v[16:19], 0
    v_mfma_f32_16x16x32_bf16 v[44:47], v[180:183], v[20:23], v[44:47]
    v_mfma_f32_16x16x32_bf16 v[44:47], v[184:187], v[24:27], v[44:47]
    v_mfma_f32_16x16x32_bf16 v[44:47], v[188:191], v[28:31], v[44:47]
    v_mfma_f32_16x16x32_bf16 v[32:35], v[128:131], v[16:19], 0
    v_mfma_f32_16x16x32_bf16 v[32:35], v[132:135], v[20:23], v[32:35]
    s_nop 0
    v_mov_b32_dpp v36, v40 quad_perm:[0,1,2,3] row_mask:0xf bank_mask:0x4
    v_mov_b32_dpp v37, v41 quad_perm:[0,1,2,3] row_mask:0xf bank_mask:0x4
    v_mfma_f32_16x16x32_bf16 v[32:35], v[136:139], v[24:27], v[32:35]
    v_mov_b32_dpp v38, v42 quad_perm:[0,1,2,3] row_mask:0xf bank_mask:0x4
    v_mov_b32_dpp v39, v43 quad_perm:[0,1,2,3] row_mask:0xf bank_mask:0x4
    v_mfma_f32_16x16x32_bf16 v[32:35], v[140:143], v[28:31], v[32:35]
    v_mov_b32_dpp v36, v44 quad_perm:[0,1,2,3] row_mask:0xf bank_mask:0x8
    v_mov_b32_dpp v37, v45 quad_perm:[0,1,2,3] row_mask:0xf bank_mask:0x8
    v_mov_b32_dpp v38, v46 quad_perm:[0,1,2,3] row_mask:0xf bank_mask:0x8
    v_mov_b32_dpp v39, v47 quad_perm:[0,1,2,3] row_mask:0xf bank_mask:0x8
    s_nop 3
    v_mov_b32_dpp v36, v32 quad_perm:[0,1,2,3] row_mask:0xf bank_mask:0x1
    v_mov_b32_dpp v37, v33 quad_perm:[0,1,2,3] row_mask:0xf bank_mask:0x1
    v_mov_b32_dpp v38, v34 quad_perm:[0,1,2,3] row_mask:0xf bank_mask:0x1
    v_mov_b32_dpp v39, v35 quad_perm:[0,1,2,3] row_mask:0xf bank_mask:0x1
    v_max3_f32 v60, v36, v37, v51
    v_max3_f32 v61, v61, v38, v39
    v_max_f32 v60, v60, v61
    s_nop 1
    v_max_f32_dpp v60, v60, v60 row_ror:4 row_mask:0xf bank_mask:0xf
    s_nop 1
    v_max_f32_dpp v60, v60, v60 row_ror:8 row_mask:0xf bank_mask:0xf
    v_mov_b32 v61, v60
    s_nop 1
    v_permlane16_swap_b32 v60, v61
    v_max_f32 v60, v60, v61
    v_mov_b32 v61, v60
    s_nop 1
    v_permlane32_swap_b32 v60, v61
    v_max_f32 v60, v60, v61
    v_mul_f32 v60, s29, v60
    v_fma_f32 v36, v36, s29, -v60
    v_fma_f32 v37, v37, s29, -v60
    v_fma_f32 v38, v38, s29, -v60
    v_fma_f32 v39, v39, s29, -v60
    v_fma_f32 v48, v48, s29, -v60
    v_fma_f32 v49, v49, s29, -v60
    v_fma_f32 v50, v50, s29, -v60
    v_fma_f32 v51, v51, s29, -v60
    v_exp_f32 v36, v36
    v_exp_f32 v37, v37
    v_exp_f32 v38, v38
    v_exp_f32 v39, v39
    v_exp_f32 v48, v48
    v_exp_f32 v49, v49
    v_exp_f32 v50, v50
    v_exp_f32 v51, v51
    ds_write_b32 v10, v60
    v_cvt_pk_bf16_f32 v16, v36, v37
    v_cvt_pk_bf16_f32 v17, v38, v39
    v_cvt_pk_bf16_f32 v18, v48, v49
    v_cvt_pk_bf16_f32 v19, v50, v51
    ds_write_b64 v8, v[16:17]
    s_mov_b64 exec, s[62:63]
    ds_write_b64 v9, v[18:19]
    s_mov_b64 exec, -1
    v_add_f32 v61, v36, v37
    v_add_f32 v62, v38, v39
    v_add_f32 v48, v48, v49
    v_add_f32 v50, v50, v51
    v_add_f32 v61, v61, v62
    v_add_f32 v48, v48, v50
    v_add_f32 v61, v61, v48
    s_cmp_eq_u32 s38, 0
    s_waitcnt lgkmcnt(0)
    s_barrier
    s_cbranch_scc1 L_ret
L_b1:
    ds_read_b128 v[16:19], v12 offset:0
    ds_read_b32 v62, v11
    ds_read_b128 v[20:23], v12 offset:256
    ds_read_b128 v[24:27], v56 offset:0
    ds_read_b128 v[28:31], v56 offset:256
    ds_read_b128 v[32:35], v57 offset:0
    ds_read_b128 v[36:39], v57 offset:256
    ds_read_b128 v[40:43], v58 offset:0
    ds_read_b128 v[44:47], v58 offset:256
    v_add_f32_dpp v61, v61, v61 row_ror:4 row_mask:0xf bank_mask:0xf
    s_nop 1
    v_add_f32_dpp v61, v61, v61 row_ror:8 row_mask:0xf bank_mask:0xf
    v_mov_b32 v0, v61
    s_nop 1
    v_permlane16_swap_b32 v61, v0
    v_add_f32 v61, v61, v0
    v_mov_b32 v0, v61
    s_nop 1
    v_permlane32_swap_b32 v61, v0
    v_add_f32 v61, v61, v0
    s_waitcnt lgkmcnt(8)
    v_mfma_f32_16x16x32_bf16 v[48:51], a[72:75], v[16:19], 0
    v_mfma_f32_16x16x32_bf16 v[52:55], a[76:79], v[16:19], 0
    ds_read_b128 v[16:19], v59 offset:0
    s_waitcnt lgkmcnt(7)
    v_mfma_f32_16x16x32_bf16 v[48:51], a[80:83], v[20:23], v[48:51]
    v_mfma_f32_16x16x32_bf16 v[52:55], a[84:87], v[20:23], v[52:55]
    s_waitcnt lgkmcnt(6)
    v_mfma_f32_16x16x32_bf16 v[48:51], a[88:91], v[24:27], v[48:51]
    v_max_f32_dpp v20, v62, v62 row_ror:4 row_mask:0xf bank_mask:0xf
    v_xor_b32 v8, 0x1000, v8
    v_mfma_f32_16x16x32_bf16 v[52:55], a[92:95], v[24:27], v[52:55]
    v_max_f32_dpp v20, v20, v20 row_ror:8 row_mask:0xf bank_mask:0xf
    v_xor_b32 v9, 0x1000, v9
    s_waitcnt lgkmcnt(5)
    v_mfma_f32_16x16x32_bf16 v[48:51], a[96:99], v[28:31], v[48:51]
    v_ceil_f32 v20, v20
    v_xor_b32 v10, 0x1000, v10
    v_mfma_f32_16x16x32_bf16 v[52:55], a[100:103], v[28:31], v[52:55]
    v_sub_f32 v0, v62, v20
    v_sub_f32 v21, v60, v20
    s_waitcnt lgkmcnt(4)
    v_mfma_f32_16x16x32_bf16 v[48:51], a[104:107], v[32:35], v[48:51]
    v_exp_f32 v21, v21
    v_exp_f32 v0, v0
    v_mfma_f32_16x16x32_bf16 v[52:55], a[108:111], v[32:35], v[52:55]
    v_mul_f32 v21, v21, v61
    v_xor_b32 v11, 0x1000, v11
    s_waitcnt lgkmcnt(3)
    v_mfma_f32_16x16x32_bf16 v[48:51], a[112:115], v[36:39], v[48:51]
    v_mfma_f32_16x16x32_bf16 v[52:55], a[116:119], v[36:39], v[52:55]
    s_waitcnt lgkmcnt(2)
    v_mfma_f32_16x16x32_bf16 v[48:51], a[120:123], v[40:43], v[48:51]
    v_xor_b32 v12, 0x1000, v12
    v_mfma_f32_16x16x32_bf16 v[52:55], a[124:127], v[40:43], v[52:55]
    v_xor_b32 v56, 0x1000, v56
    s_waitcnt lgkmcnt(1)
    v_mfma_f32_16x16x32_bf16 v[48:51], a[128:131], v[44:47], v[48:51]
    v_xor_b32 v57, 0x1000, v57
    v_mfma_f32_16x16x32_bf16 v[52:55], a[132:135], v[44:47], v[52:55]
    v_xor_b32 v58, 0x1000, v58
    s_mov_b64 exec, 15
    s_cmp_eq_u32 s4, 0
    s_cbranch_scc1 Lg_9
    buffer_store_dwordx2 v[20:21], v15, s[16:19], s64 offen
Lb_10:
    s_mov_b64 exec, -1
    s_waitcnt lgkmcnt(0)
    v_mfma_f32_16x16x32_bf16 v[48:51], a[136:139], v[16:19], v[48:51]
    v_xor_b32 v59, 0x1000, v59
    v_mfma_f32_16x16x32_bf16 v[52:55], a[140:143], v[16:19], v[52:55]
    s_nop 5
    v_mul_f32 v48, v48, v0
    v_mul_f32 v49, v49, v0
    v_mul_f32 v50, v50, v0
    v_mul_f32 v51, v51, v0
    v_mul_f32 v52, v52, v0
    v_mul_f32 v53, v53, v0
    v_mul_f32 v54, v54, v0
    v_mul_f32 v55, v55, v0
    v_add_f32_dpp v48, v48, v48 row_ror:8 row_mask:0xf bank_mask:0xf
    v_add_f32_dpp v49, v49, v49 row_ror:8 row_mask:0xf bank_mask:0xf
    v_add_f32_dpp v50, v50, v50 row_ror:8 row_mask:0xf bank_mask:0xf
    v_add_f32_dpp v51, v51, v51 row_ror:8 row_mask:0xf bank_mask:0xf
    v_add_f32_dpp v52, v52, v52 row_ror:8 row_mask:0xf bank_mask:0xf
    v_add_f32_dpp v53, v53, v53 row_ror:8 row_mask:0xf bank_mask:0xf
    v_add_f32_dpp v54, v54, v54 row_ror:8 row_mask:0xf bank_mask:0xf
    v_add_f32_dpp v55, v55, v55 row_ror:8 row_mask:0xf bank_mask:0xf
    v_add_f32_dpp v48, v48, v48 row_ror:4 row_mask:0xf bank_mask:0x5
    v_add_f32_dpp v49, v49, v49 row_ror:4 row_mask:0xf bank_mask:0x5
    v_add_f32_dpp v50, v50, v50 row_ror:4 row_mask:0xf bank_mask:0x5
    v_add_f32_dpp v51, v51, v51 row_ror:4 row_mask:0xf bank_mask:0x5
    v_add_f32_dpp v48, v52, v52 row_ror:4 row_mask:0xf bank_mask:0xa
    v_add_f32_dpp v49, v53, v53 row_ror:4 row_mask:0xf bank_mask:0xa
    v_add_f32_dpp v50, v54, v54 row_ror:4 row_mask:0xf bank_mask:0xa
    v_add_f32_dpp v51, v55, v55 row_ror:4 row_mask:0xf bank_mask:0xa
    v_cvt_pk_bf16_f32 v48, v48, v49
    v_cvt_pk_bf16_f32 v49, v50, v51
    s_mov_b64 exec, s[56:57]
    s_cmp_eq_u32 s4, 0
    s_cbranch_scc1 Lg_11
    buffer_store_dwordx2 v[48:49], v14, s[16:19], s64 offen
Lb_12:
    s_mov_b64 exec, -1
    s_setpc_b64 s[30:31]
L_aq2:
    s_sub_u32 s66, s66, 1
    s_cbranch_scc1 L_end
    buffer_load_dwordx4 v[44:47], v13, s[16:19], s65 offen sc1
    s_waitcnt vmcnt(0)
L_a2:
    v_max3_u32 v60, v44, v45, v46
    v_max_u32 v60, v60, v47
    v_cmp_eq_u32 vcc, -1, v60
    s_nop 0
    s_cbranch_vccnz L_aq2
    ds_write_b128 v6, v[44:47]
    s_waitcnt lgkmcnt(0)
    s_barrier
L_ar2:
    ds_read_b128 v[16:19], v1 offset:0
    ds_read_b128 v[20:23], v1 offset:64
    ds_read_b128 v[24:27], v1 offset:128
    ds_read_b128 v[28:31], v1 offset:192
    s_waitcnt lgkmcnt(3)
    v_mfma_f32_16x16x32_bf16 v[48:51], a[232:235], v[16:19], 0
    s_waitcnt lgkmcnt(2)
    v_mfma_f32_16x16x32_bf16 v[48:51], a[236:239], v[20:23], v[48:51]
    s_waitcnt lgkmcnt(1)
    v_mfma_f32_16x16x32_bf16 v[48:51], a[240:243], v[24:27], v[48:51]
    s_waitcnt lgkmcnt(0)
    v_mfma_f32_16x16x32_bf16 v[48:51], a[244:247], v[28:31], v[48:51]
    v_mfma_f32_16x16x32_bf16 v[36:39], v[208:211], v[16:19], 0
    v_mfma_f32_16x16x32_bf16 v[36:39], v[212:215], v[20:23], v[36:39]
    v_mfma_f32_16x16x32_bf16 v[36:39], v[216:219], v[24:27], v[36:39]
    v_mfma_f32_16x16x32_bf16 v[36:39], v[220:223], v[28:31], v[36:39]
    v_mfma_f32_16x16x32_bf16 v[40:43], v[224:227], v[16:19], 0
    v_mfma_f32_16x16x32_bf16 v[40:43], v[228:231], v[20:23], v[40:43]
    s_nop 1
    v_cndmask_b32 v48, v63, v48, s[60:61]
    v_cndmask_b32 v49, v63, v49, s[60:61]
    v_mfma_f32_16x16x32_bf16 v[40:43], v[232:235], v[24:27], v[40:43]
    v_cndmask_b32 v50, v63, v50, s[60:61]
    v_cndmask_b32 v51, v63, v51, s[60:61]
    v_mfma_f32_16x16x32_bf16 v[40:43], v[236:239], v[28:31], v[40:43]
    v_max3_f32 v61, v48, v49, v50
    v_mfma_f32_16x16x32_bf16 v[44:47], v[240:243], v[16:19], 0
    v_mfma_f32_16x16x32_bf16 v[44:47], v[244:247], v[20:23], v[44:47]
    v_mfma_f32_16x16x32_bf16 v[44:47], v[248:251], v[24:27], v[44:47]
    v_mfma_f32_16x16x32_bf16 v[44:47], v[252:255], v[28:31], v[44:47]
    v_mfma_f32_16x16x32_bf16 v[32:35], v[192:195], v[16:19], 0
    v_mfma_f32_16x16x32_bf16 v[32:35], v[196:199], v[20:23], v[32:35]
    s_nop 0
    v_mov_b32_dpp v36, v40 quad_perm:[0,1,2,3] row_mask:0xf bank_mask:0x4
    v_mov_b32_dpp v37, v41 quad_perm:[0,1,2,3] row_mask:0xf bank_mask:0x4
    v_mfma_f32_16x16x32_bf16 v[32:35], v[200:203], v[24:27], v[32:35]
    v_mov_b32_dpp v38, v42 quad_perm:[0,1,2,3] row_mask:0xf bank_mask:0x4
    v_mov_b32_dpp v39, v43 quad_perm:[0,1,2,3] row_mask:0xf bank_mask:0x4
    v_mfma_f32_16x16x32_bf16 v[32:35], v[204:207], v[28:31], v[32:35]
    v_mov_b32_dpp v36, v44 quad_perm:[0,1,2,3] row_mask:0xf bank_mask:0x8
    v_mov_b32_dpp v37, v45 quad_perm:[0,1,2,3] row_mask:0xf bank_mask:0x8
    v_mov_b32_dpp v38, v46 quad_perm:[0,1,2,3] row_mask:0xf bank_mask:0x8
    v_mov_b32_dpp v39, v47 quad_perm:[0,1,2,3] row_mask:0xf bank_mask:0x8
    s_nop 3
    v_mov_b32_dpp v36, v32 quad_perm:[0,1,2,3] row_mask:0xf bank_mask:0x1
    v_mov_b32_dpp v37, v33 quad_perm:[0,1,2,3] row_mask:0xf bank_mask:0x1
    v_mov_b32_dpp v38, v34 quad_perm:[0,1,2,3] row_mask:0xf bank_mask:0x1
    v_mov_b32_dpp v39, v35 quad_perm:[0,1,2,3] row_mask:0xf bank_mask:0x1
    v_max3_f32 v60, v36, v37, v51
    v_max3_f32 v61, v61, v38, v39
    v_max_f32 v60, v60, v61
    s_nop 1
    v_max_f32_dpp v60, v60, v60 row_ror:4 row_mask:0xf bank_mask:0xf
    s_nop 1
    v_max_f32_dpp v60, v60, v60 row_ror:8 row_mask:0xf bank_mask:0xf
    v_mov_b32 v61, v60
    s_nop 1
    v_permlane16_swap_b32 v60, v61
    v_max_f32 v60, v60, v61
    v_mov_b32 v61, v60
    s_nop 1
    v_permlane32_swap_b32 v60, v61
    v_max_f32 v60, v60, v61
    v_mul_f32 v60, s29, v60
    v_fma_f32 v36, v36, s29, -v60
    v_fma_f32 v37, v37, s29, -v60
    v_fma_f32 v38, v38, s29, -v60
    v_fma_f32 v39, v39, s29, -v60
    v_fma_f32 v48, v48, s29, -v60
    v_fma_f32 v49, v49, s29, -v60
    v_fma_f32 v50, v50, s29, -v60
    v_fma_f32 v51, v51, s29, -v60
    v_exp_f32 v36, v36
    v_exp_f32 v37, v37
    v_exp_f32 v38, v38
    v_exp_f32 v39, v39
    v_exp_f32 v48, v48
    v_exp_f32 v49, v49
    v_exp_f32 v50, v50
    v_exp_f32 v51, v51
    ds_write_b32 v10, v60
    v_cvt_pk_bf16_f32 v16, v36, v37
    v_cvt_pk_bf16_f32 v17, v38, v39
    v_cvt_pk_bf16_f32 v18, v48, v49
    v_cvt_pk_bf16_f32 v19, v50, v51
    ds_write_b64 v8, v[16:17]
    s_mov_b64 exec, s[60:61]
    ds_write_b64 v9, v[18:19]
    s_mov_b64 exec, -1
    v_add_f32 v61, v36, v37
    v_add_f32 v62, v38, v39
    v_add_f32 v48, v48, v49
    v_add_f32 v50, v50, v51
    v_add_f32 v61, v61, v62
    v_add_f32 v48, v48, v50
    v_add_f32 v61, v61, v48
    s_cmp_eq_u32 s38, 0
    s_waitcnt lgkmcnt(0)
    s_barrier
    s_cbranch_scc1 L_ret
L_b2:
    ds_read_b128 v[16:19], v12 offset:0
    ds_read_b32 v62, v11
    ds_read_b128 v[20:23], v12 offset:256
    ds_read_b128 v[24:27], v56 offset:0
    ds_read_b128 v[28:31], v56 offset:256
    ds_read_b128 v[32:35], v57 offset:0
    ds_read_b128 v[36:39], v57 offset:256
    ds_read_b128 v[40:43], v58 offset:0
    ds_read_b128 v[44:47], v58 offset:256
    v_add_f32_dpp v61, v61, v61 row_ror:4 row_mask:0xf bank_mask:0xf
    s_nop 1
    v_add_f32_dpp v61, v61, v61 row_ror:8 row_mask:0xf bank_mask:0xf
    v_mov_b32 v0, v61
    s_nop 1
    v_permlane16_swap_b32 v61, v0
    v_add_f32 v61, v61, v0
    v_mov_b32 v0, v61
    s_nop 1
    v_permlane32_swap_b32 v61, v0
    v_add_f32 v61, v61, v0
    s_waitcnt lgkmcnt(8)
    v_mfma_f32_16x16x32_bf16 v[48:51], a[144:147], v[16:19], 0
    v_mfma_f32_16x16x32_bf16 v[52:55], a[148:151], v[16:19], 0
    ds_read_b128 v[16:19], v59 offset:0
    s_waitcnt lgkmcnt(7)
    v_mfma_f32_16x16x32_bf16 v[48:51], a[152:155], v[20:23], v[48:51]
    v_mfma_f32_16x16x32_bf16 v[52:55], a[156:159], v[20:23], v[52:55]
    s_waitcnt lgkmcnt(6)
    v_mfma_f32_16x16x32_bf16 v[48:51], a[160:163], v[24:27], v[48:51]
    v_max_f32_dpp v20, v62, v62 row_ror:4 row_mask:0xf bank_mask:0xf
    v_xor_b32 v8, 0x1000, v8
    v_mfma_f32_16x16x32_bf16 v[52:55], a[164:167], v[24:27], v[52:55]
    v_max_f32_dpp v20, v20, v20 row_ror:8 row_mask:0xf bank_mask:0xf
    v_xor_b32 v9, 0x1000, v9
    s_waitcnt lgkmcnt(5)
    v_mfma_f32_16x16x32_bf16 v[48:51], a[168:171], v[28:31], v[48:51]
    v_ceil_f32 v20, v20
    v_xor_b32 v10, 0x1000, v10
    v_mfma_f32_16x16x32_bf16 v[52:55], a[172:175], v[28:31], v[52:55]
    v_sub_f32 v0, v62, v20
    v_sub_f32 v21, v60, v20
    s_waitcnt lgkmcnt(4)
    v_mfma_f32_16x16x32_bf16 v[48:51], a[176:179], v[32:35], v[48:51]
    v_exp_f32 v21, v21
    v_exp_f32 v0, v0
    v_mfma_f32_16x16x32_bf16 v[52:55], a[180:183], v[32:35], v[52:55]
    v_mul_f32 v21, v21, v61
    v_xor_b32 v11, 0x1000, v11
    s_waitcnt lgkmcnt(3)
    v_mfma_f32_16x16x32_bf16 v[48:51], a[184:187], v[36:39], v[48:51]
    v_mfma_f32_16x16x32_bf16 v[52:55], a[188:191], v[36:39], v[52:55]
    s_waitcnt lgkmcnt(2)
    v_mfma_f32_16x16x32_bf16 v[48:51], a[192:195], v[40:43], v[48:51]
    v_xor_b32 v12, 0x1000, v12
    v_mfma_f32_16x16x32_bf16 v[52:55], a[196:199], v[40:43], v[52:55]
    v_xor_b32 v56, 0x1000, v56
    s_waitcnt lgkmcnt(1)
    v_mfma_f32_16x16x32_bf16 v[48:51], a[200:203], v[44:47], v[48:51]
    v_xor_b32 v57, 0x1000, v57
    v_mfma_f32_16x16x32_bf16 v[52:55], a[204:207], v[44:47], v[52:55]
    v_xor_b32 v58, 0x1000, v58
    s_mov_b64 exec, 15
    s_cmp_eq_u32 s4, 0
    s_cbranch_scc1 Lg_13
    buffer_store_dwordx2 v[20:21], v15, s[16:19], s64 offen
Lb_14:
    s_mov_b64 exec, -1
    s_waitcnt lgkmcnt(0)
    v_mfma_f32_16x16x32_bf16 v[48:51], a[208:211], v[16:19], v[48:51]
    v_xor_b32 v59, 0x1000, v59
    v_mfma_f32_16x16x32_bf16 v[52:55], a[212:215], v[16:19], v[52:55]
    s_nop 5
    v_mul_f32 v48, v48, v0
    v_mul_f32 v49, v49, v0
    v_mul_f32 v50, v50, v0
    v_mul_f32 v51, v51, v0
    v_mul_f32 v52, v52, v0
    v_mul_f32 v53, v53, v0
    v_mul_f32 v54, v54, v0
    v_mul_f32 v55, v55, v0
    v_add_f32_dpp v48, v48, v48 row_ror:8 row_mask:0xf bank_mask:0xf
    v_add_f32_dpp v49, v49, v49 row_ror:8 row_mask:0xf bank_mask:0xf
    v_add_f32_dpp v50, v50, v50 row_ror:8 row_mask:0xf bank_mask:0xf
    v_add_f32_dpp v51, v51, v51 row_ror:8 row_mask:0xf bank_mask:0xf
    v_add_f32_dpp v52, v52, v52 row_ror:8 row_mask:0xf bank_mask:0xf
    v_add_f32_dpp v53, v53, v53 row_ror:8 row_mask:0xf bank_mask:0xf
    v_add_f32_dpp v54, v54, v54 row_ror:8 row_mask:0xf bank_mask:0xf
    v_add_f32_dpp v55, v55, v55 row_ror:8 row_mask:0xf bank_mask:0xf
    v_add_f32_dpp v48, v48, v48 row_ror:4 row_mask:0xf bank_mask:0x5
    v_add_f32_dpp v49, v49, v49 row_ror:4 row_mask:0xf bank_mask:0x5
    v_add_f32_dpp v50, v50, v50 row_ror:4 row_mask:0xf bank_mask:0x5
    v_add_f32_dpp v51, v51, v51 row_ror:4 row_mask:0xf bank_mask:0x5
    v_add_f32_dpp v48, v52, v52 row_ror:4 row_mask:0xf bank_mask:0xa
    v_add_f32_dpp v49, v53, v53 row_ror:4 row_mask:0xf bank_mask:0xa
    v_add_f32_dpp v50, v54, v54 row_ror:4 row_mask:0xf bank_mask:0xa
    v_add_f32_dpp v51, v55, v55 row_ror:4 row_mask:0xf bank_mask:0xa
    v_cvt_pk_bf16_f32 v48, v48, v49
    v_cvt_pk_bf16_f32 v49, v50, v51
    s_mov_b64 exec, s[56:57]
    s_cmp_eq_u32 s4, 0
    s_cbranch_scc1 Lg_15
    buffer_store_dwordx2 v[48:49], v14, s[16:19], s64 offen
Lb_16:
    s_mov_b64 exec, -1
    s_setpc_b64 s[30:31]
L_dq:
L_dq2:
    s_sub_u32 s66, s66, 1
    s_cbranch_scc1 L_end
    buffer_load_dwordx4 v[248:251], v193, s[16:19], s65 offen sc1
    s_waitcnt vmcnt(0)
    v_max3_u32 v60, v248, v249, v250
    v_max_u32 v60, v60, v251
    v_cmp_eq_u32 vcc, -1, v60
    s_nop 0
    s_cbranch_vccnz L_dq2
    ds_write_b128 v194, v[248:251]
    s_waitcnt lgkmcnt(0)
    s_barrier
    ds_read_b128 v[16:19], v1 offset:0
    ds_read_b128 v[20:23], v1 offset:64
    ds_read_b128 v[24:27], v1 offset:128
    ds_read_b128 v[28:31], v1 offset:192
    ds_read_b128 v[208:211], v1 offset:1088
    ds_read_b128 v[212:215], v1 offset:1152
    ds_read_b128 v[216:219], v1 offset:1216
    ds_read_b128 v[220:223], v1 offset:1280
    s_waitcnt lgkmcnt(7)
    v_mfma_f32_16x16x32_bf16 v[48:51], a[216:219], v[16:19], 0
    s_waitcnt lgkmcnt(6)
    v_mfma_f32_16x16x32_bf16 v[48:51], a[220:223], v[20:23], v[48:51]
    s_waitcnt lgkmcnt(5)
    v_mfma_f32_16x16x32_bf16 v[48:51], a[224:227], v[24:27], v[48:51]
    s_waitcnt lgkmcnt(4)
    v_mfma_f32_16x16x32_bf16 v[48:51], a[228:231], v[28:31], v[48:51]
    v_mfma_f32_16x16x32_bf16 v[36:39], v[80:83], v[16:19], 0
    v_mfma_f32_16x16x32_bf16 v[36:39], v[84:87], v[20:23], v[36:39]
    v_mfma_f32_16x16x32_bf16 v[36:39], v[88:91], v[24:27], v[36:39]
    v_mfma_f32_16x16x32_bf16 v[36:39], v[92:95], v[28:31], v[36:39]
    v_mfma_f32_16x16x32_bf16 v[40:43], v[96:99], v[16:19], 0
    v_mfma_f32_16x16x32_bf16 v[40:43], v[100:103], v[20:23], v[40:43]
    v_mfma_f32_16x16x32_bf16 v[40:43], v[104:107], v[24:27], v[40:43]
    v_mfma_f32_16x16x32_bf16 v[40:43], v[108:111], v[28:31], v[40:43]
    v_mfma_f32_16x16x32_bf16 v[44:47], v[112:115], v[16:19], 0
    v_mfma_f32_16x16x32_bf16 v[44:47], v[116:119], v[20:23], v[44:47]
    v_mfma_f32_16x16x32_bf16 v[44:47], v[120:123], v[24:27], v[44:47]
    v_mfma_f32_16x16x32_bf16 v[44:47], v[124:127], v[28:31], v[44:47]
    v_mfma_f32_16x16x32_bf16 v[32:35], v[64:67], v[16:19], 0
    v_mfma_f32_16x16x32_bf16 v[32:35], v[68:71], v[20:23], v[32:35]
    v_mfma_f32_16x16x32_bf16 v[32:35], v[72:75], v[24:27], v[32:35]
    v_mfma_f32_16x16x32_bf16 v[32:35], v[76:79], v[28:31], v[32:35]
    s_waitcnt lgkmcnt(0)
    v_mfma_f32_16x16x32_bf16 v[240:243], a[216:219], v[208:211], 0
    v_mfma_f32_16x16x32_bf16 v[240:243], a[220:223], v[212:215], v[240:243]
    v_mfma_f32_16x16x32_bf16 v[240:243], a[224:227], v[216:219], v[240:243]
    v_cndmask_b32 v48, v63, v48, s[60:61]
    v_cndmask_b32 v49, v63, v49, s[60:61]
    v_mfma_f32_16x16x32_bf16 v[240:243], a[228:231], v[220:223], v[240:243]
    v_cndmask_b32 v50, v63, v50, s[60:61]
    v_cndmask_b32 v51, v63, v51, s[60:61]
    v_mfma_f32_16x16x32_bf16 v[228:231], v[144:147], v[208:211], 0
    v_mov_b32_dpp v36, v40 quad_perm:[0,1,2,3] row_mask:0xf bank_mask:0x4
    v_mov_b32_dpp v37, v41 quad_perm:[0,1,2,3] row_mask:0xf bank_mask:0x4
    v_mfma_f32_16x16x32_bf16 v[228:231], v[148:151], v[212:215], v[228:231]
    v_mov_b32_dpp v38, v42 quad_perm:[0,1,2,3] row_mask:0xf bank_mask:0x4
    v_mov_b32_dpp v39, v43 quad_perm:[0,1,2,3] row_mask:0xf bank_mask:0x4
    v_mfma_f32_16x16x32_bf16 v[228:231], v[152:155], v[216:219], v[228:231]
    v_mov_b32_dpp v36, v44 quad_perm:[0,1,2,3] row_mask:0xf bank_mask:0x8
    v_mov_b32_dpp v37, v45 quad_perm:[0,1,2,3] row_mask:0xf bank_mask:0x8
    v_mfma_f32_16x16x32_bf16 v[228:231], v[156:159], v[220:223], v[228:231]
    v_mov_b32_dpp v38, v46 quad_perm:[0,1,2,3] row_mask:0xf bank_mask:0x8
    v_mov_b32_dpp v39, v47 quad_perm:[0,1,2,3] row_mask:0xf bank_mask:0x8
    v_mfma_f32_16x16x32_bf16 v[232:235], v[160:163], v[208:211], 0
    v_mov_b32_dpp v36, v32 quad_perm:[0,1,2,3] row_mask:0xf bank_mask:0x1
    v_mov_b32_dpp v37, v33 quad_perm:[0,1,2,3] row_mask:0xf bank_mask:0x1
    v_mfma_f32_16x16x32_bf16 v[232:235], v[164:167], v[212:215], v[232:235]
    v_mov_b32_dpp v38, v34 quad_perm:[0,1,2,3] row_mask:0xf bank_mask:0x1
    v_mov_b32_dpp v39, v35 quad_perm:[0,1,2,3] row_mask:0xf bank_mask:0x1
    v_mfma_f32_16x16x32_bf16 v[232:235], v[168:171], v[216:219], v[232:235]
    v_max3_f32 v61, v48, v49, v50
    v_max3_f32 v60, v36, v37, v51
    v_mfma_f32_16x16x32_bf16 v[232:235], v[172:175], v[220:223], v[232:235]
    v_max3_f32 v61, v61, v38, v39
    v_max_f32 v60, v60, v61
    v_mfma_f32_16x16x32_bf16 v[236:239], v[176:179], v[208:211], 0
    s_nop 0
    v_max_f32_dpp v60, v60, v60 row_ror:4 row_mask:0xf bank_mask:0xf
    s_nop 1
    v_max_f32_dpp v60, v60, v60 row_ror:8 row_mask:0xf bank_mask:0xf
    v_mfma_f32_16x16x32_bf16 v[236:239], v[180:183], v[212:215], v[236:239]
    v_mov_b32 v61, v60
    s_nop 1
    v_permlane16_swap_b32 v60, v61
    v_mfma_f32_16x16x32_bf16 v[236:239], v[184:187], v[216:219], v[236:239]
    v_max_f32 v60, v60, v61
    v_mov_b32 v61, v60
    v_mfma_f32_16x16x32_bf16 v[236:239], v[188:191], v[220:223], v[236:239]
    s_nop 0
    v_permlane32_swap_b32 v60, v61
    v_max_f32 v60, v60, v61
    v_mfma_f32_16x16x32_bf16 v[224:227], v[128:131], v[208:211], 0
    v_mul_f32 v60, s29, v60
    v_fma_f32 v36, v36, s29, -v60
    v_mfma_f32_16x16x32_bf16 v[224:227], v[132:135], v[212:215], v[224:227]
    v_fma_f32 v37, v37, s29, -v60
    v_fma_f32 v38, v38, s29, -v60
    v_mfma_f32_16x16x32_bf16 v[224:227], v[136:139], v[216:219], v[224:227]
    v_fma_f32 v39, v39, s29, -v60
    v_fma_f32 v48, v48, s29, -v60
    v_mfma_f32_16x16x32_bf16 v[224:227], v[140:143], v[220:223], v[224:227]
    v_fma_f32 v49, v49, s29, -v60
    v_fma_f32 v50, v50, s29, -v60
    v_fma_f32 v51, v51, s29, -v60
    v_cndmask_b32 v240, v63, v240, s[62:63]
    v_exp_f32 v36, v36
    v_cndmask_b32 v241, v63, v241, s[62:63]
    v_exp_f32 v37, v37
    v_cndmask_b32 v242, v63, v242, s[62:63]
    v_exp_f32 v38, v38
    v_cndmask_b32 v243, v63, v243, s[62:63]
    v_exp_f32 v39, v39
    v_mov_b32_dpp v228, v232 quad_perm:[0,1,2,3] row_mask:0xf bank_mask:0x4
    v_exp_f32 v48, v48
    v_mov_b32_dpp v229, v233 quad_perm:[0,1,2,3] row_mask:0xf bank_mask:0x4
    v_exp_f32 v49, v49
    v_mov_b32_dpp v230, v234 quad_perm:[0,1,2,3] row_mask:0xf bank_mask:0x4
    v_exp_f32 v50, v50
    v_mov_b32_dpp v231, v235 quad_perm:[0,1,2,3] row_mask:0xf bank_mask:0x4
    v_exp_f32 v51, v51
    v_mov_b32_dpp v228, v236 quad_perm:[0,1,2,3] row_mask:0xf bank_mask:0x8
    ds_write_b32 v10, v60 offset:0
    v_mov_b32_dpp v229, v237 quad_perm:[0,1,2,3] row_mask:0xf bank_mask:0x8
    v_cvt_pk_bf16_f32 v16, v36, v37
    v_mov_b32_dpp v230, v238 quad_perm:[0,1,2,3] row_mask:0xf bank_mask:0x8
    v_cvt_pk_bf16_f32 v17, v38, v39
    v_mov_b32_dpp v231, v239 quad_perm:[0,1,2,3] row_mask:0xf bank_mask:0x8
    v_cvt_pk_bf16_f32 v18, v48, v49
    v_mov_b32_dpp v228, v224 quad_perm:[0,1,2,3] row_mask:0xf bank_mask:0x1
    v_cvt_pk_bf16_f32 v19, v50, v51
    v_mov_b32_dpp v229, v225 quad_perm:[0,1,2,3] row_mask:0xf bank_mask:0x1
    ds_write_b64 v8, v[16:17] offset:0
    v_mov_b32_dpp v230, v226 quad_perm:[0,1,2,3] row_mask:0xf bank_mask:0x1
    s_mov_b64 exec, s[60:61]
    ds_write_b64 v9, v[18:19] offset:0
    s_mov_b64 exec, -1
    s_nop 0
    v_mov_b32_dpp v231, v227 quad_perm:[0,1,2,3] row_mask:0xf bank_mask:0x1
    v_add_f32 v61, v36, v37
    v_max3_f32 v253, v240, v241, v242
    v_add_f32 v62, v38, v39
    v_max3_f32 v252, v228, v229, v243
    v_add_f32 v48, v48, v49
    v_max3_f32 v253, v253, v230, v231
    v_add_f32 v50, v50, v51
    v_max_f32 v252, v252, v253
    v_add_f32 v61, v61, v62
    s_nop 0
    v_max_f32_dpp v252, v252, v252 row_ror:4 row_mask:0xf bank_mask:0xf
    v_add_f32 v48, v48, v50
    s_nop 0
    v_max_f32_dpp v252, v252, v252 row_ror:8 row_mask:0xf bank_mask:0xf
    v_add_f32 v61, v61, v48
    v_mov_b32 v253, v252
    s_nop 1
    v_permlane16_swap_b32 v252, v253
    v_max_f32 v252, v252, v253
    v_mov_b32 v253, v252
    s_nop 1
    v_permlane32_swap_b32 v252, v253
    v_max_f32 v252, v252, v253
    v_mul_f32 v252, s29, v252
    v_fma_f32 v228, v228, s29, -v252
    v_fma_f32 v229, v229, s29, -v252
    v_fma_f32 v230, v230, s29, -v252
    v_fma_f32 v231, v231, s29, -v252
    v_fma_f32 v240, v240, s29, -v252
    v_fma_f32 v241, v241, s29, -v252
    v_fma_f32 v242, v242, s29, -v252
    v_fma_f32 v243, v243, s29, -v252
    v_exp_f32 v228, v228
    v_exp_f32 v229, v229
    v_exp_f32 v230, v230
    v_exp_f32 v231, v231
    v_exp_f32 v240, v240
    v_exp_f32 v241, v241
    v_exp_f32 v242, v242
    v_exp_f32 v243, v243
    ds_write_b32 v10, v252 offset:4096
    v_cvt_pk_bf16_f32 v208, v228, v229
    v_cvt_pk_bf16_f32 v209, v230, v231
    v_cvt_pk_bf16_f32 v210, v240, v241
    v_cvt_pk_bf16_f32 v211, v242, v243
    ds_write_b64 v8, v[208:209] offset:4096
    s_mov_b64 exec, s[62:63]
    ds_write_b64 v9, v[210:211] offset:4096
    s_mov_b64 exec, -1
    v_add_f32 v253, v228, v229
    v_add_f32 v254, v230, v231
    v_add_f32 v240, v240, v241
    v_add_f32 v242, v242, v243
    v_add_f32 v253, v253, v254
    v_add_f32 v240, v240, v242
    v_add_f32 v253, v253, v240
    s_waitcnt lgkmcnt(0)
    s_barrier
    ds_read_b32 v62, v11
    ds_read_b32 v254, v11 offset:4096
    ds_read_b128 v[16:19], v12 offset:0
    ds_read_b128 v[20:23], v12 offset:256
    ds_read_b128 v[24:27], v56 offset:0
    ds_read_b128 v[28:31], v56 offset:256
    ds_read_b128 v[32:35], v57 offset:0
    ds_read_b128 v[36:39], v57 offset:256
    ds_read_b128 v[40:43], v58 offset:0
    ds_read_b128 v[44:47], v58 offset:256
    ds_read_b128 v[200:203], v59 offset:0
    s_waitcnt lgkmcnt(8)
    v_mfma_f32_16x16x32_bf16 v[48:51], a[0:3], v[16:19], 0
    v_add_f32_dpp v61, v61, v61 row_ror:4 row_mask:0xf bank_mask:0xf
    v_add_f32_dpp v253, v253, v253 row_ror:4 row_mask:0xf bank_mask:0xf
    v_mfma_f32_16x16x32_bf16 v[52:55], a[4:7], v[16:19], 0
    v_add_f32_dpp v61, v61, v61 row_ror:8 row_mask:0xf bank_mask:0xf
    v_add_f32_dpp v253, v253, v253 row_ror:8 row_mask:0xf bank_mask:0xf
    ds_read_b128 v[208:211], v12 offset:4096
    s_waitcnt lgkmcnt(8)
    v_mfma_f32_16x16x32_bf16 v[48:51], a[8:11], v[20:23], v[48:51]
    v_mov_b32 v0, v61
    v_mov_b32 v195, v253
    v_mfma_f32_16x16x32_bf16 v[52:55], a[12:15], v[20:23], v[52:55]
    v_permlane16_swap_b32 v61, v0
    v_permlane16_swap_b32 v253, v195
    ds_read_b128 v[212:215], v12 offset:4352
    s_waitcnt lgkmcnt(8)
    v_mfma_f32_16x16x32_bf16 v[48:51], a[16:19], v[24:27], v[48:51]
    v_add_f32 v61, v61, v0
    v_add_f32 v253, v253, v195
    v_mfma_f32_16x16x32_bf16 v[52:55], a[20:23], v[24:27], v[52:55]
    v_mov_b32 v0, v61
    v_mov_b32 v195, v253
    ds_read_b128 v[216:219], v56 offset:4096
    s_waitcnt lgkmcnt(8)
    v_mfma_f32_16x16x32_bf16 v[48:51], a[24:27], v[28:31], v[48:51]
    v_permlane32_swap_b32 v61, v0
    v_permlane32_swap_b32 v253, v195
    v_mfma_f32_16x16x32_bf16 v[52:55], a[28:31], v[28:31], v[52:55]
    v_add_f32 v61, v61, v0
    v_add_f32 v253, v253, v195
    ds_read_b128 v[220:223], v56 offset:4352
    s_waitcnt lgkmcnt(8)
    v_mfma_f32_16x16x32_bf16 v[48:51], a[32:35], v[32:35], v[48:51]
    v_max_f32_dpp v196, v62, v62 row_ror:4 row_mask:0xf bank_mask:0xf
    v_max_f32_dpp v198, v254, v254 row_ror:4 row_mask:0xf bank_mask:0xf
    v_mfma_f32_16x16x32_bf16 v[52:55], a[36:39], v[32:35], v[52:55]
    v_max_f32_dpp v196, v196, v196 row_ror:8 row_mask:0xf bank_mask:0xf
    v_max_f32_dpp v198, v198, v198 row_ror:8 row_mask:0xf bank_mask:0xf
    ds_read_b128 v[224:227], v57 offset:4096
    s_waitcnt lgkmcnt(8)
    v_mfma_f32_16x16x32_bf16 v[48:51], a[40:43], v[36:39], v[48:51]
    v_ceil_f32 v196, v196
    v_ceil_f32 v198, v198
    v_mfma_f32_16x16x32_bf16 v[52:55], a[44:47], v[36:39], v[52:55]
    v_sub_f32 v0, v62, v196
    v_sub_f32 v195, v254, v198
    ds_read_b128 v[228:231], v57 offset:4352
    s_waitcnt lgkmcnt(8)
    v_mfma_f32_16x16x32_bf16 v[48:51], a[48:51], v[40:43], v[48:51]
    v_sub_f32 v197, v60, v196
    v_sub_f32 v199, v252, v198
    v_mfma_f32_16x16x32_bf16 v[52:55], a[52:55], v[40:43], v[52:55]
    v_exp_f32 v197, v197
    v_exp_f32 v199, v199
    ds_read_b128 v[232:235], v58 offset:4096
    s_waitcnt lgkmcnt(8)
    v_mfma_f32_16x16x32_bf16 v[48:51], a[56:59], v[44:47], v[48:51]
    v_exp_f32 v0, v0
    v_exp_f32 v195, v195
    v_mfma_f32_16x16x32_bf16 v[52:55], a[60:63], v[44:47], v[52:55]
    v_mul_f32 v197, v197, v61
    v_mul_f32 v199, v199, v253
    ds_read_b128 v[236:239], v58 offset:4352
    s_waitcnt lgkmcnt(8)
    v_mfma_f32_16x16x32_bf16 v[48:51], a[64:67], v[200:203], v[48:51]
    v_mfma_f32_16x16x32_bf16 v[52:55], a[68:71], v[200:203], v[52:55]
    ds_read_b128 v[204:207], v59 offset:4096
    s_waitcnt lgkmcnt(8)
    v_mfma_f32_16x16x32_bf16 v[240:243], a[72:75], v[208:211], 0
    v_mfma_f32_16x16x32_bf16 v[244:247], a[76:79], v[208:211], 0
    s_waitcnt lgkmcnt(7)
    v_mfma_f32_16x16x32_bf16 v[240:243], a[80:83], v[212:215], v[240:243]
    v_mfma_f32_16x16x32_bf16 v[244:247], a[84:87], v[212:215], v[244:247]
    s_waitcnt lgkmcnt(6)
    v_mfma_f32_16x16x32_bf16 v[240:243], a[88:91], v[216:219], v[240:243]
    v_mul_f32 v48, v48, v0
    v_mul_f32 v49, v49, v0
    v_mfma_f32_16x16x32_bf16 v[244:247], a[92:95], v[216:219], v[244:247]
    v_mul_f32 v50, v50, v0
    v_mul_f32 v51, v51, v0
    s_waitcnt lgkmcnt(5)
    v_mfma_f32_16x16x32_bf16 v[240:243], a[96:99], v[220:223], v[240:243]
    v_mul_f32 v52, v52, v0
    v_mul_f32 v53, v53, v0
    v_mfma_f32_16x16x32_bf16 v[244:247], a[100:103], v[220:223], v[244:247]
    v_mul_f32 v54, v54, v0
    v_mul_f32 v55, v55, v0
    s_waitcnt lgkmcnt(4)
    v_mfma_f32_16x16x32_bf16 v[240:243], a[104:107], v[224:227], v[240:243]
    v_add_f32_dpp v48, v48, v48 row_ror:8 row_mask:0xf bank_mask:0xf
    v_add_f32_dpp v49, v49, v49 row_ror:8 row_mask:0xf bank_mask:0xf
    v_mfma_f32_16x16x32_bf16 v[244:247], a[108:111], v[224:227], v[244:247]
    v_add_f32_dpp v50, v50, v50 row_ror:8 row_mask:0xf bank_mask:0xf
    v_add_f32_dpp v51, v51, v51 row_ror:8 row_mask:0xf bank_mask:0xf
    s_waitcnt lgkmcnt(3)
    v_mfma_f32_16x16x32_bf16 v[240:243], a[112:115], v[228:231], v[240:243]
    v_add_f32_dpp v52, v52, v52 row_ror:8 row_mask:0xf bank_mask:0xf
    v_add_f32_dpp v53, v53, v53 row_ror:8 row_mask:0xf bank_mask:0xf
    v_mfma_f32_16x16x32_bf16 v[244:247], a[116:119], v[228:231], v[244:247]
    v_add_f32_dpp v54, v54, v54 row_ror:8 row_mask:0xf bank_mask:0xf
    v_add_f32_dpp v55, v55, v55 row_ror:8 row_mask:0xf bank_mask:0xf
    s_waitcnt lgkmcnt(2)
    v_mfma_f32_16x16x32_bf16 v[240:243], a[120:123], v[232:235], v[240:243]
    v_add_f32_dpp v48, v48, v48 row_ror:4 row_mask:0xf bank_mask:0x5
    v_add_f32_dpp v49, v49, v49 row_ror:4 row_mask:0xf bank_mask:0x5
    v_mfma_f32_16x16x32_bf16 v[244:247], a[124:127], v[232:235], v[244:247]
    v_add_f32_dpp v50, v50, v50 row_ror:4 row_mask:0xf bank_mask:0x5
    v_add_f32_dpp v51, v51, v51 row_ror:4 row_mask:0xf bank_mask:0x5
    s_waitcnt lgkmcnt(1)
    v_mfma_f32_16x16x32_bf16 v[240:243], a[128:131], v[236:239], v[240:243]
    v_add_f32_dpp v48, v52, v52 row_ror:4 row_mask:0xf bank_mask:0xa
    v_add_f32_dpp v49, v53, v53 row_ror:4 row_mask:0xf bank_mask:0xa
    v_mfma_f32_16x16x32_bf16 v[244:247], a[132:135], v[236:239], v[244:247]
    v_add_f32_dpp v50, v54, v54 row_ror:4 row_mask:0xf bank_mask:0xa
    v_add_f32_dpp v51, v55, v55 row_ror:4 row_mask:0xf bank_mask:0xa
    s_waitcnt lgkmcnt(0)
    v_mfma_f32_16x16x32_bf16 v[240:243], a[136:139], v[204:207], v[240:243]
    v_cvt_pk_bf16_f32 v48, v48, v49
    v_cvt_pk_bf16_f32 v49, v50, v51
    v_mfma_f32_16x16x32_bf16 v[244:247], a[140:143], v[204:207], v[244:247]
    s_mov_b64 exec, s[56:57]
    s_cmp_eq_u32 s4, 0
    s_cbranch_scc1 Lg_17
    buffer_store_dwordx2 v[48:49], v14, s[16:19], s64 offen
Lb_18:
    s_mov_b64 exec, -1
    s_mov_b64 exec, 15
    s_cmp_eq_u32 s4, 0
    s_cbranch_scc1 Lg_19
    buffer_store_dwordx2 v[196:197], v15, s[16:19], s64 offen
    buffer_store_dwordx2 v[198:199], v15, s[16:19], s70 offen
Lb_20:
    s_mov_b64 exec, -1
    v_mul_f32 v240, v240, v195
    v_mul_f32 v241, v241, v195
    v_mul_f32 v242, v242, v195
    v_mul_f32 v243, v243, v195
    v_mul_f32 v244, v244, v195
    v_mul_f32 v245, v245, v195
    v_mul_f32 v246, v246, v195
    v_mul_f32 v247, v247, v195
    v_add_f32_dpp v240, v240, v240 row_ror:8 row_mask:0xf bank_mask:0xf
    v_add_f32_dpp v241, v241, v241 row_ror:8 row_mask:0xf bank_mask:0xf
    v_add_f32_dpp v242, v242, v242 row_ror:8 row_mask:0xf bank_mask:0xf
    v_add_f32_dpp v243, v243, v243 row_ror:8 row_mask:0xf bank_mask:0xf
    v_add_f32_dpp v244, v244, v244 row_ror:8 row_mask:0xf bank_mask:0xf
    v_add_f32_dpp v245, v245, v245 row_ror:8 row_mask:0xf bank_mask:0xf
    v_add_f32_dpp v246, v246, v246 row_ror:8 row_mask:0xf bank_mask:0xf
    v_add_f32_dpp v247, v247, v247 row_ror:8 row_mask:0xf bank_mask:0xf
    v_add_f32_dpp v240, v240, v240 row_ror:4 row_mask:0xf bank_mask:0x5
    v_add_f32_dpp v241, v241, v241 row_ror:4 row_mask:0xf bank_mask:0x5
    v_add_f32_dpp v242, v242, v242 row_ror:4 row_mask:0xf bank_mask:0x5
    v_add_f32_dpp v243, v243, v243 row_ror:4 row_mask:0xf bank_mask:0x5
    v_add_f32_dpp v240, v244, v244 row_ror:4 row_mask:0xf bank_mask:0xa
    v_add_f32_dpp v241, v245, v245 row_ror:4 row_mask:0xf bank_mask:0xa
    v_add_f32_dpp v242, v246, v246 row_ror:4 row_mask:0xf bank_mask:0xa
    v_add_f32_dpp v243, v247, v247 row_ror:4 row_mask:0xf bank_mask:0xa
    v_cvt_pk_bf16_f32 v240, v240, v241
    v_cvt_pk_bf16_f32 v241, v242, v243
    s_mov_b64 exec, s[56:57]
    s_cmp_eq_u32 s4, 0
    s_cbranch_scc1 Lg_21
    buffer_store_dwordx2 v[240:241], v14, s[16:19], s70 offen
Lb_22:
    s_mov_b64 exec, -1
    s_setpc_b64 s[30:31]
L_ret:
    s_setpc_b64 s[30:31]
L_service:
    s_sub_u32 s71, s26, 28
    v_lshlrev_b32 v44, 1, v40
    v_xor_b32 v44, v44, v41
    v_lshlrev_b32 v240, 4, v44
    v_xor_b32 v241, 128, v240
    v_lshl_add_u32 v242, v40, 13, v240
    v_lshl_add_u32 v243, v40, 13, v241
    s_lshl_b32 s32, s24, 13
    s_lshl_b32 s67, s25, 2
    s_add_u32 s67, s67, s71
    s_lshl_b32 s34, s67, 8
    s_lshl_b32 s68, s24, 18
    s_add_u32 s34, s34, s68
    v_lshlrev_b32 v248, 3, v1
    s_lshl_b32 s67, s24, 10
    s_waitcnt lgkmcnt(0)
    buffer_load_dwordx2 v[96:97], v248, s[56:59], s67 offen offset:0
    buffer_load_dwordx2 v[98:99], v248, s[56:59], s67 offen offset:512
    s_add_u32 s67, s67, 4096
    buffer_load_dwordx2 v[100:101], v248, s[56:59], s67 offen offset:0
    buffer_load_dwordx2 v[102:103], v248, s[56:59], s67 offen offset:512
    s_add_u32 m0, s32, 0
    s_add_u32 s0, s34, 0
    buffer_load_dwordx4 v242, s[76:79], s0 offen nt lds
    s_add_u32 m0, s32, 1024
    s_add_u32 s0, s34, 32768
    buffer_load_dwordx4 v243, s[76:79], s0 offen nt lds
    s_add_u32 m0, s32, 2048
    s_add_u32 s0, s34, 65536
    buffer_load_dwordx4 v242, s[76:79], s0 offen nt lds
    s_add_u32 m0, s32, 3072
    s_add_u32 s0, s34, 98304
    buffer_load_dwordx4 v243, s[76:79], s0 offen nt lds
    s_add_u32 m0, s32, 4096
    s_add_u32 s0, s34, 131072
    buffer_load_dwordx4 v242, s[76:79], s0 offen nt lds
    s_add_u32 m0, s32, 5120
    s_add_u32 s0, s34, 163840
    buffer_load_dwordx4 v243, s[76:79], s0 offen nt lds
    s_add_u32 m0, s32, 6144
    s_add_u32 s0, s34, 196608
    buffer_load_dwordx4 v242, s[76:79], s0 offen nt lds
    s_add_u32 m0, s32, 7168
    s_add_u32 s0, s34, 229376
    buffer_load_dwordx4 v243, s[76:79], s0 offen nt lds
    s_mul_i32 s67, s25, 415744
    s_add_u32 s67, s67, 1048576
    s_add_u32 s16, s92, s67
    s_addc_u32 s17, s93, 0
    s_mov_b32 s18, 415744
    s_mov_b32 s19, 0x20000
    s_mov_b32 s29, 0x3e0293ee
    s_mov_b32 s56, 0x00ff00ff
    s_mov_b32 s57, 0x00ff00ff
    s_mov_b32 s58, 0xff00ff00
    s_mov_b32 s59, 0xff00ff00
    s_mov_b32 s60, 0x000f000f
    s_mov_b32 s61, 0
    s_mov_b32 s62, 0
    s_mov_b32 s63, 0x000f000f
    s_mov_b32 s66, 0x10000
    s_mov_b64 s[4:5], 0
    s_getreg_b32 s67, hwreg(HW_REG_XCC_ID, 0, 4)
    s_mul_i32 s68, s67, s67
    s_lshl_b32 s67, s67, 24
    s_or_b32 s72, s67, s68
    s_mov_b32 s73, 0x10000
    v_lshlrev_b32 v44, 8, v42
    v_lshl_add_u32 v13, v40, 4, v44
    s_mul_i32 s67, s26, 1024
    s_lshl_b32 s68, s24, 6
    s_add_u32 s68, s68, s67
    v_lshlrev_b32 v44, 8, v42
    v_lshl_add_u32 v44, v40, 3, v44
    v_and_b32 v45, 1, v43
    v_lshl_add_u32 v44, v45, 5, v44
    v_add_u32 v14, s68, v44
    s_lshl_b32 s68, s24, 3
    s_lshl_b32 s67, s26, 5
    s_add_u32 s68, s68, s67
    s_add_u32 s68, s68, 32768
    v_lshlrev_b32 v44, 10, v42
    v_add_u32 v15, s68, v44
    v_lshl_add_u32 v44, v40, 2, v43
    v_and_b32 v45, 7, v44
    s_lshl_b32 s67, s24, 1
    v_xor_b32 v45, s67, v45
    v_lshlrev_b32 v45, 5, v45
    v_lshl_add_u32 v45, v44, 8, v45
    v_lshl_add_u32 v5, v42, 3, v45
    v_lshl_add_u32 v44, v40, 3, v43
    v_xor_b32 v45, s67, v43
    v_lshlrev_b32 v45, 5, v45
    v_lshl_add_u32 v45, v44, 8, v45
    v_lshl_add_u32 v7, v42, 3, v45
    v_mov_b32 v44, s72
    v_mov_b32 v45, s73
    s_lshl_b32 s67, s25, 5
    s_cmp_eq_u32 s24, 0
    s_cselect_b64 exec, 1, 0
    buffer_atomic_add_x2 v[44:45], off, s[20:23], s67 sc1
    s_mov_b64 exec, -1
    v_lshl_add_u32 v244, v40, 10, v240
    v_lshl_add_u32 v245, v40, 10, v241
    s_lshl_b32 s35, s25, 19
    s_lshl_b32 s68, s71, 8
    s_lshl_b32 s67, s24, 15
    s_add_u32 s68, s68, s67
    s_add_u32 s35, s35, s68
    s_mul_i32 s37, s25, 229376
    s_add_u32 s37, s37, s68
    s_mul_i32 s36, s25, 448
    s_lshl_b32 s68, s71, 7
    s_add_u32 s36, s36, s68
    s_mul_i32 s68, s24, 229376
    s_add_u32 s36, s36, s68
    v_lshrrev_b32 v44, 3, v1
    s_movk_i32 s67, 3584
    v_mul_lo_u32 v44, v44, s67
    v_and_b32 v45, 7, v1
    v_lshl_add_u32 v246, v45, 4, v44
    v_lshl_add_u32 v44, v40, 3, v43
    v_lshlrev_b32 v44, 7, v44
    v_lshl_add_u32 v44, v42, 3, v44
    s_lshl_b32 s67, s24, 5
    v_add_u32 v247, s67, v44
    s_lshl_b32 s27, s25, 21
    s_lshl_b32 s67, s71, 13
    s_add_u32 s27, s27, s67
    s_add_u32 s27, s27, 2064384
    s_lshl_b32 s1, s24, 11
    s_add_u32 s27, s27, s1
    v_lshl_add_u32 v132, v40, 8, v240
    v_lshl_add_u32 v133, v40, 8, v241
    s_movk_i32 s70, 1088
    v_mul_lo_u32 v44, v43, s70
    v_lshl_add_u32 v45, v40, 4, v44
    v_lshl_add_u32 v45, v42, 6, v45
    v_add_u32 v2, 131072, v45
    v_mul_lo_u32 v44, v40, s70
    v_lshl_add_u32 v45, v41, 4, v44
    v_add_u32 v34, 154432, v45
    v_and_b32 v45, 7, v41
    v_mul_lo_u32 v44, v45, s70
    v_lshl_add_u32 v44, v40, 4, v44
    v_add_u32 v249, 135424, v44
    s_lshl_b32 s67, s25, 11
    s_lshl_b32 s68, s71, 9
    s_add_u32 s67, s67, s68
    s_lshl_b32 s68, s24, 7
    s_add_u32 s67, s67, s68
    v_lshrrev_b32 v44, 5, v1
    v_lshlrev_b32 v44, 14, v44
    v_and_b32 v45, 31, v1
    v_lshl_add_u32 v44, v45, 2, v44
    v_add_u32 v3, s67, v44
    s_lshl_b32 s67, s71, 8
    s_lshl_b32 s68, s24, 6
    s_add_u32 s67, s67, s68
    v_and_b32 v44, 1, v41
    v_lshlrev_b32 v44, 5, v44
    v_and_b32 v45, 14, v41
    v_lshl_add_u32 v44, v45, 1, v44
    v_add_u32 v44, s67, v44
    v_lshl_add_u32 v4, v40, 10, v44
    v_lshl_add_u32 v252, v40, 12, v44
    s_lshl_b32 s68, s71, 7
    s_lshl_b32 s69, s24, 5
    s_add_u32 s68, s68, s69
    v_lshlrev_b32 v44, 9, v40
    v_lshl_add_u32 v44, v41, 1, v44
    v_add_u32 v8, s68, v44
    s_lshl_b32 s68, s71, 8
    s_lshl_b32 s67, s24, 6
    s_add_u32 s68, s68, s67
    v_lshlrev_b32 v45, 4, v42
    v_add_u32 v45, s68, v45
    v_lshrrev_b32 v44, 2, v1
    v_lshl_add_u32 v11, v44, 10, v45
    v_lshl_add_u32 v32, v40, 2, v45
    s_lshl_b32 s68, s71, 10
    s_add_u32 s68, s68, 32768
    v_lshlrev_b32 v44, 3, v1
    v_add_u32 v12, s68, v44
    v_and_b32 v44, 7, v41
    v_lshlrev_b32 v44, 1, v44
    v_xor_b32 v44, v44, v40
    v_lshlrev_b32 v44, 4, v44
    v_lshl_add_u32 v33, v41, 8, v44
    v_lshlrev_b32 v44, 4, v41
    v_lshl_add_u32 v44, v40, 11, v44
    s_lshl_b32 s67, s24, 9
    v_add_u32 v36, s67, v44
    v_bfe_u32 v44, v1, 3, 1
    v_lshrrev_b32 v45, 5, v1
    v_lshl_add_u32 v44, v45, 1, v44
    v_lshlrev_b32 v44, 6, v44
    v_and_b32 v45, 1, v40
    v_lshl_add_u32 v44, v45, 5, v44
    v_lshl_add_u32 v44, v42, 3, v44
    s_lshl_b32 s67, s24, 8
    v_add_u32 v35, s67, v44
    v_and_b32 v44, 1, v43
    v_mul_lo_u32 v44, v44, s70
    v_add_u32 v45, v44, v35
    v_add_u32 v37, 135424, v45
    v_lshrrev_b32 v45, 5, v35
    v_lshl_add_u32 v45, v45, 3, v44
    v_add_u32 v9, 154432, v45
    s_mov_b32 s39, 0xffff0000
    s_mov_b32 s62, 0x55555555
    s_mov_b32 s63, 0x55555555
    v_mov_b32 v52, 0x3f803f80
    v_mov_b32 v53, 0x3f803f80
    v_mov_b32 v54, 0x3f803f80
    v_mov_b32 v55, 0x3f803f80
    v_mov_b32 v6, v43
    v_add_u32 v44, 153408, v47
    ds_write_b128 v44, v[52:55]
    s_waitcnt vmcnt(8)
    s_add_u32 m0, s32, 32768
    s_add_u32 s0, s34, 1048576
    buffer_load_dwordx4 v242, s[76:79], s0 offen nt lds
    s_add_u32 m0, s32, 33792
    s_add_u32 s0, s34, 1081344
    buffer_load_dwordx4 v243, s[76:79], s0 offen nt lds
    s_add_u32 m0, s32, 34816
    s_add_u32 s0, s34, 1114112
    buffer_load_dwordx4 v242, s[76:79], s0 offen nt lds
    s_add_u32 m0, s32, 35840
    s_add_u32 s0, s34, 1146880
    buffer_load_dwordx4 v243, s[76:79], s0 offen nt lds
    s_add_u32 m0, s32, 36864
    s_add_u32 s0, s34, 1179648
    buffer_load_dwordx4 v242, s[76:79], s0 offen nt lds
    s_add_u32 m0, s32, 37888
    s_add_u32 s0, s34, 1212416
    buffer_load_dwordx4 v243, s[76:79], s0 offen nt lds
    s_add_u32 m0, s32, 38912
    s_add_u32 s0, s34, 1245184
    buffer_load_dwordx4 v242, s[76:79], s0 offen nt lds
    s_add_u32 m0, s32, 39936
    s_add_u32 s0, s34, 1277952
    buffer_load_dwordx4 v243, s[76:79], s0 offen nt lds
    s_lshl_b32 s68, s24, 10
    s_add_u32 s68, s68, 145216
    v_add_u32 v44, s68, v248
    ds_write_b64 v44, v[96:97]
    ds_write_b64 v44, v[98:99] offset:512
    v_and_b32 v113, s39, v96
    v_lshlrev_b32 v112, 16, v96
    v_and_b32 v115, s39, v97
    v_lshlrev_b32 v114, 16, v97
    v_and_b32 v117, s39, v98
    v_lshlrev_b32 v116, 16, v98
    v_and_b32 v119, s39, v99
    v_lshlrev_b32 v118, 16, v99
    s_mul_i32 s68, s24, 1088
    s_add_u32 s68, s68, 135424
    v_add_u32 v250, s68, v248
    v_add_f32 v40, v112, v113
    v_mul_f32 v41, v112, v112
    v_fmac_f32 v41, v113, v113
    v_add_f32 v40, v40, v114
    v_fmac_f32 v41, v114, v114
    v_add_f32 v40, v40, v115
    v_fmac_f32 v41, v115, v115
    v_add_f32 v40, v40, v116
    v_fmac_f32 v41, v116, v116
    v_add_f32 v40, v40, v117
    v_fmac_f32 v41, v117, v117
    v_add_f32 v40, v40, v118
    v_fmac_f32 v41, v118, v118
    v_add_f32 v40, v40, v119
    v_fmac_f32 v41, v119, v119
    s_nop 0
    v_add_f32_dpp v40, v40, v40 row_ror:1 row_mask:0xf bank_mask:0xf
    v_add_f32_dpp v41, v41, v41 row_ror:1 row_mask:0xf bank_mask:0xf
    s_nop 0
    v_add_f32_dpp v40, v40, v40 row_ror:2 row_mask:0xf bank_mask:0xf
    v_add_f32_dpp v41, v41, v41 row_ror:2 row_mask:0xf bank_mask:0xf
    s_nop 0
    v_add_f32_dpp v40, v40, v40 row_ror:4 row_mask:0xf bank_mask:0xf
    v_add_f32_dpp v41, v41, v41 row_ror:4 row_mask:0xf bank_mask:0xf
    s_nop 0
    v_add_f32_dpp v40, v40, v40 row_ror:8 row_mask:0xf bank_mask:0xf
    v_add_f32_dpp v41, v41, v41 row_ror:8 row_mask:0xf bank_mask:0xf
    v_mov_b32 v42, v40
    v_mov_b32 v43, v41
    s_nop 0
    v_permlane16_swap_b32 v40, v42
    v_permlane16_swap_b32 v41, v43
    v_add_f32 v40, v40, v42
    v_add_f32 v41, v41, v43
    v_mov_b32 v42, v40
    v_mov_b32 v43, v41
    s_nop 0
    v_permlane32_swap_b32 v40, v42
    v_permlane32_swap_b32 v41, v43
    v_add_f32 v40, v40, v42
    v_add_f32 v41, v41, v43
    v_mul_f32 v40, 0x3b000000, v40
    v_mul_f32 v41, 0x3b000000, v41
    v_fma_f32 v41, -v40, v40, v41
    v_cvt_pk_bf16_f32 v40, v40, v40
    v_max_f32 v41, 0, v41
    v_and_b32 v40, s39, v40
    v_cvt_pk_bf16_f32 v41, v41, v41
    v_and_b32 v41, s39, v41
    v_add_f32 v41, 0x3727c5ac, v41
    v_cvt_pk_bf16_f32 v41, v41, v41
    v_and_b32 v41, s39, v41
    v_sqrt_f32 v41, v41
    s_nop 0
    v_cvt_pk_bf16_f32 v41, v41, v41
    v_and_b32 v41, s39, v41
    v_rcp_f32 v41, v41
    v_sub_f32 v48, v112, v40
    v_sub_f32 v49, v113, v40
    v_sub_f32 v50, v114, v40
    v_sub_f32 v51, v115, v40
    v_sub_f32 v52, v116, v40
    v_sub_f32 v53, v117, v40
    v_sub_f32 v54, v118, v40
    v_sub_f32 v55, v119, v40
    v_cvt_pk_bf16_f32 v56, v48, v49
    v_cvt_pk_bf16_f32 v57, v50, v51
    v_cvt_pk_bf16_f32 v58, v52, v53
    v_cvt_pk_bf16_f32 v59, v54, v55
    v_and_b32 v49, s39, v56
    v_lshlrev_b32 v48, 16, v56
    v_and_b32 v51, s39, v57
    v_lshlrev_b32 v50, 16, v57
    v_and_b32 v53, s39, v58
    v_lshlrev_b32 v52, 16, v58
    v_and_b32 v55, s39, v59
    v_lshlrev_b32 v54, 16, v59
    v_mul_f32 v48, v48, v41
    v_mul_f32 v49, v49, v41
    v_mul_f32 v50, v50, v41
    v_mul_f32 v51, v51, v41
    v_mul_f32 v52, v52, v41
    v_mul_f32 v53, v53, v41
    v_mul_f32 v54, v54, v41
    v_mul_f32 v55, v55, v41
    v_cvt_pk_bf16_f32 v56, v48, v49
    v_cvt_pk_bf16_f32 v57, v50, v51
    v_cvt_pk_bf16_f32 v58, v52, v53
    v_cvt_pk_bf16_f32 v59, v54, v55
    ds_write_b64 v250, v[56:57]
    ds_write_b64 v250, v[58:59] offset:512
    s_add_u32 m0, s32, 65536
    s_add_u32 s0, s34, 2097152
    buffer_load_dwordx4 v242, s[76:79], s0 offen nt lds
    s_add_u32 m0, s32, 66560
    s_add_u32 s0, s34, 2129920
    buffer_load_dwordx4 v243, s[76:79], s0 offen nt lds
    s_add_u32 m0, s32, 67584
    s_add_u32 s0, s34, 2162688
    buffer_load_dwordx4 v242, s[76:79], s0 offen nt lds
    s_add_u32 m0, s32, 68608
    s_add_u32 s0, s34, 2195456
    buffer_load_dwordx4 v243, s[76:79], s0 offen nt lds
    s_add_u32 m0, s32, 69632
    s_add_u32 s0, s34, 2228224
    buffer_load_dwordx4 v242, s[76:79], s0 offen nt lds
    s_add_u32 m0, s32, 70656
    s_add_u32 s0, s34, 2260992
    buffer_load_dwordx4 v243, s[76:79], s0 offen nt lds
    s_add_u32 m0, s32, 71680
    s_add_u32 s0, s34, 2293760
    buffer_load_dwordx4 v242, s[76:79], s0 offen nt lds
    s_add_u32 m0, s32, 72704
    s_add_u32 s0, s34, 2326528
    buffer_load_dwordx4 v243, s[76:79], s0 offen nt lds
    s_lshl_b32 s68, s24, 10
    s_add_u32 s68, s68, 149312
    v_add_u32 v44, s68, v248
    ds_write_b64 v44, v[100:101]
    ds_write_b64 v44, v[102:103] offset:512
    v_and_b32 v113, s39, v100
    v_lshlrev_b32 v112, 16, v100
    v_and_b32 v115, s39, v101
    v_lshlrev_b32 v114, 16, v101
    v_and_b32 v117, s39, v102
    v_lshlrev_b32 v116, 16, v102
    v_and_b32 v119, s39, v103
    v_lshlrev_b32 v118, 16, v103
    s_mul_i32 s68, s24, 1088
    s_add_u32 s68, s68, 139776
    v_add_u32 v250, s68, v248
    v_add_f32 v40, v112, v113
    v_mul_f32 v41, v112, v112
    v_fmac_f32 v41, v113, v113
    v_add_f32 v40, v40, v114
    v_fmac_f32 v41, v114, v114
    v_add_f32 v40, v40, v115
    v_fmac_f32 v41, v115, v115
    v_add_f32 v40, v40, v116
    v_fmac_f32 v41, v116, v116
    v_add_f32 v40, v40, v117
    v_fmac_f32 v41, v117, v117
    v_add_f32 v40, v40, v118
    v_fmac_f32 v41, v118, v118
    v_add_f32 v40, v40, v119
    v_fmac_f32 v41, v119, v119
    s_nop 0
    v_add_f32_dpp v40, v40, v40 row_ror:1 row_mask:0xf bank_mask:0xf
    v_add_f32_dpp v41, v41, v41 row_ror:1 row_mask:0xf bank_mask:0xf
    s_nop 0
    v_add_f32_dpp v40, v40, v40 row_ror:2 row_mask:0xf bank_mask:0xf
    v_add_f32_dpp v41, v41, v41 row_ror:2 row_mask:0xf bank_mask:0xf
    s_nop 0
    v_add_f32_dpp v40, v40, v40 row_ror:4 row_mask:0xf bank_mask:0xf
    v_add_f32_dpp v41, v41, v41 row_ror:4 row_mask:0xf bank_mask:0xf
    s_nop 0
    v_add_f32_dpp v40, v40, v40 row_ror:8 row_mask:0xf bank_mask:0xf
    v_add_f32_dpp v41, v41, v41 row_ror:8 row_mask:0xf bank_mask:0xf
    v_mov_b32 v42, v40
    v_mov_b32 v43, v41
    s_nop 0
    v_permlane16_swap_b32 v40, v42
    v_permlane16_swap_b32 v41, v43
    v_add_f32 v40, v40, v42
    v_add_f32 v41, v41, v43
    v_mov_b32 v42, v40
    v_mov_b32 v43, v41
    s_nop 0
    v_permlane32_swap_b32 v40, v42
    v_permlane32_swap_b32 v41, v43
    v_add_f32 v40, v40, v42
    v_add_f32 v41, v41, v43
    v_mul_f32 v40, 0x3b000000, v40
    v_mul_f32 v41, 0x3b000000, v41
    v_fma_f32 v41, -v40, v40, v41
    v_cvt_pk_bf16_f32 v40, v40, v40
    v_max_f32 v41, 0, v41
    v_and_b32 v40, s39, v40
    v_cvt_pk_bf16_f32 v41, v41, v41
    v_and_b32 v41, s39, v41
    v_add_f32 v41, 0x3727c5ac, v41
    v_cvt_pk_bf16_f32 v41, v41, v41
    v_and_b32 v41, s39, v41
    v_sqrt_f32 v41, v41
    s_nop 0
    v_cvt_pk_bf16_f32 v41, v41, v41
    v_and_b32 v41, s39, v41
    v_rcp_f32 v41, v41
    v_sub_f32 v48, v112, v40
    v_sub_f32 v49, v113, v40
    v_sub_f32 v50, v114, v40
    v_sub_f32 v51, v115, v40
    v_sub_f32 v52, v116, v40
    v_sub_f32 v53, v117, v40
    v_sub_f32 v54, v118, v40
    v_sub_f32 v55, v119, v40
    v_cvt_pk_bf16_f32 v56, v48, v49
    v_cvt_pk_bf16_f32 v57, v50, v51
    v_cvt_pk_bf16_f32 v58, v52, v53
    v_cvt_pk_bf16_f32 v59, v54, v55
    v_and_b32 v49, s39, v56
    v_lshlrev_b32 v48, 16, v56
    v_and_b32 v51, s39, v57
    v_lshlrev_b32 v50, 16, v57
    v_and_b32 v53, s39, v58
    v_lshlrev_b32 v52, 16, v58
    v_and_b32 v55, s39, v59
    v_lshlrev_b32 v54, 16, v59
    v_mul_f32 v48, v48, v41
    v_mul_f32 v49, v49, v41
    v_mul_f32 v50, v50, v41
    v_mul_f32 v51, v51, v41
    v_mul_f32 v52, v52, v41
    v_mul_f32 v53, v53, v41
    v_mul_f32 v54, v54, v41
    v_mul_f32 v55, v55, v41
    v_cvt_pk_bf16_f32 v56, v48, v49
    v_cvt_pk_bf16_f32 v57, v50, v51
    v_cvt_pk_bf16_f32 v58, v52, v53
    v_cvt_pk_bf16_f32 v59, v54, v55
    ds_write_b64 v250, v[56:57]
    ds_write_b64 v250, v[58:59] offset:512
    s_add_u32 m0, s32, 98304
    s_add_u32 s0, s34, 3145728
    buffer_load_dwordx4 v242, s[76:79], s0 offen nt lds
    s_add_u32 m0, s32, 99328
    s_add_u32 s0, s34, 3178496
    buffer_load_dwordx4 v243, s[76:79], s0 offen nt lds
    s_add_u32 m0, s32, 100352
    s_add_u32 s0, s34, 3211264
    buffer_load_dwordx4 v242, s[76:79], s0 offen nt lds
    s_add_u32 m0, s32, 101376
    s_add_u32 s0, s34, 3244032
    buffer_load_dwordx4 v243, s[76:79], s0 offen nt lds
    s_add_u32 m0, s32, 102400
    s_add_u32 s0, s34, 3276800
    buffer_load_dwordx4 v242, s[76:79], s0 offen nt lds
    s_add_u32 m0, s32, 103424
    s_add_u32 s0, s34, 3309568
    buffer_load_dwordx4 v243, s[76:79], s0 offen nt lds
    s_add_u32 m0, s32, 104448
    s_add_u32 s0, s34, 3342336
    buffer_load_dwordx4 v242, s[76:79], s0 offen nt lds
    s_add_u32 m0, s32, 105472
    s_add_u32 s0, s34, 3375104
    buffer_load_dwordx4 v243, s[76:79], s0 offen nt lds
    s_lshl_b32 s67, s71, 2
    s_add_u32 s67, s67, s24
    s_mul_i32 s67, s67, 2304
    v_add_u32 v123, s67, v47
    s_waitcnt vmcnt(24)
    s_waitcnt lgkmcnt(0)
    s_barrier
    v_add_u32 v124, 0, v7
    v_xor_b32 v125, 128, v124
    v_xor_b32 v126, 32, v124
    v_xor_b32 v127, 160, v124
    ds_read_b64_tr_b16 a[0:1], v124 offset:0
    ds_read_b64_tr_b16 a[2:3], v125 offset:1024
    ds_read_b64_tr_b16 a[4:5], v126 offset:0
    ds_read_b64_tr_b16 a[6:7], v127 offset:1024
    ds_read_b64_tr_b16 a[8:9], v124 offset:8192
    ds_read_b64_tr_b16 a[10:11], v125 offset:9216
    ds_read_b64_tr_b16 a[12:13], v126 offset:8192
    ds_read_b64_tr_b16 a[14:15], v127 offset:9216
    ds_read_b64_tr_b16 a[16:17], v124 offset:16384
    ds_read_b64_tr_b16 a[18:19], v125 offset:17408
    ds_read_b64_tr_b16 a[20:21], v126 offset:16384
    ds_read_b64_tr_b16 a[22:23], v127 offset:17408
    ds_read_b64_tr_b16 a[24:25], v124 offset:24576
    ds_read_b64_tr_b16 a[26:27], v125 offset:25600
    ds_read_b64_tr_b16 a[28:29], v126 offset:24576
    ds_read_b64_tr_b16 a[30:31], v127 offset:25600
    s_waitcnt vmcnt(16)
    s_waitcnt lgkmcnt(0)
    s_barrier
    s_add_u32 s0, s27, 0
    s_add_u32 m0, s1, 0
    s_nop 0
    buffer_load_dwordx4 v132, s[8:11], s0 offen nt lds
    buffer_load_dwordx4 v133, s[8:11], s0 offen offset:1024 nt lds
    s_add_u32 m0, s1, 8192
    s_nop 0
    buffer_load_dwordx4 v132, s[12:15], s0 offen nt lds
    buffer_load_dwordx4 v133, s[12:15], s0 offen offset:1024 nt lds
    s_add_u32 s0, s27, 16777216
    s_add_u32 m0, s1, 16384
    s_nop 0
    buffer_load_dwordx4 v132, s[8:11], s0 offen nt lds
    buffer_load_dwordx4 v133, s[8:11], s0 offen offset:1024 nt lds
    s_add_u32 m0, s1, 24576
    s_nop 0
    buffer_load_dwordx4 v132, s[12:15], s0 offen nt lds
    buffer_load_dwordx4 v133, s[12:15], s0 offen offset:1024 nt lds
    v_add_u32 v124, 32768, v7
    v_xor_b32 v125, 128, v124
    v_xor_b32 v126, 32, v124
    v_xor_b32 v127, 160, v124
    ds_read_b64_tr_b16 a[32:33], v124 offset:0
    ds_read_b64_tr_b16 a[34:35], v125 offset:1024
    ds_read_b64_tr_b16 a[36:37], v126 offset:0
    ds_read_b64_tr_b16 a[38:39], v127 offset:1024
    ds_read_b64_tr_b16 a[40:41], v124 offset:8192
    ds_read_b64_tr_b16 a[42:43], v125 offset:9216
    ds_read_b64_tr_b16 a[44:45], v126 offset:8192
    ds_read_b64_tr_b16 a[46:47], v127 offset:9216
    ds_read_b64_tr_b16 a[48:49], v124 offset:16384
    ds_read_b64_tr_b16 a[50:51], v125 offset:17408
    ds_read_b64_tr_b16 a[52:53], v126 offset:16384
    ds_read_b64_tr_b16 a[54:55], v127 offset:17408
    ds_read_b64_tr_b16 a[56:57], v124 offset:24576
    ds_read_b64_tr_b16 a[58:59], v125 offset:25600
    ds_read_b64_tr_b16 a[60:61], v126 offset:24576
    ds_read_b64_tr_b16 a[62:63], v127 offset:25600
    s_waitcnt vmcnt(16)
    s_waitcnt lgkmcnt(0)
    s_barrier
    s_add_u32 m0, s32, 32768
    s_add_u32 s0, s35, 0
    buffer_load_dwordx4 v244, s[80:83], s0 offen nt lds
    s_add_u32 m0, s32, 33792
    s_add_u32 s0, s35, 4096
    buffer_load_dwordx4 v245, s[80:83], s0 offen nt lds
    s_add_u32 m0, s32, 34816
    s_add_u32 s0, s35, 8192
    buffer_load_dwordx4 v244, s[80:83], s0 offen nt lds
    s_add_u32 m0, s32, 35840
    s_add_u32 s0, s35, 12288
    buffer_load_dwordx4 v245, s[80:83], s0 offen nt lds
    s_add_u32 m0, s32, 36864
    s_add_u32 s0, s35, 16384
    buffer_load_dwordx4 v244, s[80:83], s0 offen nt lds
    s_add_u32 m0, s32, 37888
    s_add_u32 s0, s35, 20480
    buffer_load_dwordx4 v245, s[80:83], s0 offen nt lds
    s_add_u32 m0, s32, 38912
    s_add_u32 s0, s35, 24576
    buffer_load_dwordx4 v244, s[80:83], s0 offen nt lds
    s_add_u32 m0, s32, 39936
    s_add_u32 s0, s35, 28672
    buffer_load_dwordx4 v245, s[80:83], s0 offen nt lds
    v_add_u32 v124, 65536, v7
    v_xor_b32 v125, 128, v124
    v_xor_b32 v126, 32, v124
    v_xor_b32 v127, 160, v124
    ds_read_b64_tr_b16 a[64:65], v124 offset:0
    ds_read_b64_tr_b16 a[66:67], v125 offset:1024
    ds_read_b64_tr_b16 a[68:69], v126 offset:0
    ds_read_b64_tr_b16 a[70:71], v127 offset:1024
    ds_read_b64_tr_b16 a[72:73], v124 offset:8192
    ds_read_b64_tr_b16 a[74:75], v125 offset:9216
    ds_read_b64_tr_b16 a[76:77], v126 offset:8192
    ds_read_b64_tr_b16 a[78:79], v127 offset:9216
    ds_read_b64_tr_b16 a[80:81], v124 offset:16384
    ds_read_b64_tr_b16 a[82:83], v125 offset:17408
    ds_read_b64_tr_b16 a[84:85], v126 offset:16384
    ds_read_b64_tr_b16 a[86:87], v127 offset:17408
    ds_read_b64_tr_b16 a[88:89], v124 offset:24576
    ds_read_b64_tr_b16 a[90:91], v125 offset:25600
    ds_read_b64_tr_b16 a[92:93], v126 offset:24576
    ds_read_b64_tr_b16 a[94:95], v127 offset:25600
    s_waitcnt vmcnt(16)
    s_waitcnt lgkmcnt(0)
    s_barrier
    s_add_u32 m0, s32, 65536
    s_add_u32 s0, s35, 131072
    buffer_load_dwordx4 v244, s[80:83], s0 offen nt lds
    s_add_u32 m0, s32, 66560
    s_add_u32 s0, s35, 135168
    buffer_load_dwordx4 v245, s[80:83], s0 offen nt lds
    s_add_u32 m0, s32, 67584
    s_add_u32 s0, s35, 139264
    buffer_load_dwordx4 v244, s[80:83], s0 offen nt lds
    s_add_u32 m0, s32, 68608
    s_add_u32 s0, s35, 143360
    buffer_load_dwordx4 v245, s[80:83], s0 offen nt lds
    s_add_u32 m0, s32, 69632
    s_add_u32 s0, s35, 147456
    buffer_load_dwordx4 v244, s[80:83], s0 offen nt lds
    s_add_u32 m0, s32, 70656
    s_add_u32 s0, s35, 151552
    buffer_load_dwordx4 v245, s[80:83], s0 offen nt lds
    s_add_u32 m0, s32, 71680
    s_add_u32 s0, s35, 155648
    buffer_load_dwordx4 v244, s[80:83], s0 offen nt lds
    s_add_u32 m0, s32, 72704
    s_add_u32 s0, s35, 159744
    buffer_load_dwordx4 v245, s[80:83], s0 offen nt lds
    v_add_u32 v124, 98304, v7
    v_xor_b32 v125, 128, v124
    v_xor_b32 v126, 32, v124
    v_xor_b32 v127, 160, v124
    ds_read_b64_tr_b16 a[96:97], v124 offset:0
    ds_read_b64_tr_b16 a[98:99], v125 offset:1024
    ds_read_b64_tr_b16 a[100:101], v126 offset:0
    ds_read_b64_tr_b16 a[102:103], v127 offset:1024
    ds_read_b64_tr_b16 a[104:105], v124 offset:8192
    ds_read_b64_tr_b16 a[106:107], v125 offset:9216
    ds_read_b64_tr_b16 a[108:109], v126 offset:8192
    ds_read_b64_tr_b16 a[110:111], v127 offset:9216
    ds_read_b64_tr_b16 a[112:113], v124 offset:16384
    ds_read_b64_tr_b16 a[114:115], v125 offset:17408
    ds_read_b64_tr_b16 a[116:117], v126 offset:16384
    ds_read_b64_tr_b16 a[118:119], v127 offset:17408
    ds_read_b64_tr_b16 a[120:121], v124 offset:24576
    ds_read_b64_tr_b16 a[122:123], v125 offset:25600
    ds_read_b64_tr_b16 a[124:125], v126 offset:24576
    ds_read_b64_tr_b16 a[126:127], v127 offset:25600
    s_waitcnt lgkmcnt(0)
    ds_read_b128 v[48:51], v249 offset:0
    ds_read_b128 v[52:55], v249 offset:64
    ds_read_b128 v[56:59], v249 offset:128
    ds_read_b128 v[60:63], v249 offset:192
    ds_read_b128 v[64:67], v249 offset:256
    ds_read_b128 v[68:71], v249 offset:320
    ds_read_b128 v[72:75], v249 offset:384
    ds_read_b128 v[76:79], v249 offset:448
    ds_read_b128 v[80:83], v249 offset:512
    ds_read_b128 v[84:87], v249 offset:576
    s_waitcnt lgkmcnt(9)
    v_mfma_f32_16x16x32_bf16 v[104:107], v[48:51], a[0:3], 0
    v_mfma_f32_16x16x32_bf16 v[108:111], v[48:51], a[4:7], 0
    ds_read_b128 v[88:91], v249 offset:640
    s_waitcnt lgkmcnt(9)
    v_mfma_f32_16x16x32_bf16 v[104:107], v[52:55], a[8:11], v[104:107]
    v_mfma_f32_16x16x32_bf16 v[108:111], v[52:55], a[12:15], v[108:111]
    ds_read_b128 v[92:95], v249 offset:704
    s_waitcnt lgkmcnt(9)
    v_mfma_f32_16x16x32_bf16 v[104:107], v[56:59], a[16:19], v[104:107]
    v_mfma_f32_16x16x32_bf16 v[108:111], v[56:59], a[20:23], v[108:111]
    ds_read_b128 v[48:51], v249 offset:768
    s_waitcnt lgkmcnt(9)
    v_mfma_f32_16x16x32_bf16 v[104:107], v[60:63], a[24:27], v[104:107]
    v_mfma_f32_16x16x32_bf16 v[108:111], v[60:63], a[28:31], v[108:111]
    ds_read_b128 v[52:55], v249 offset:832
    s_waitcnt lgkmcnt(9)
    v_mfma_f32_16x16x32_bf16 v[104:107], v[64:67], a[32:35], v[104:107]
    v_mfma_f32_16x16x32_bf16 v[108:111], v[64:67], a[36:39], v[108:111]
    ds_read_b128 v[56:59], v249 offset:896
    s_waitcnt lgkmcnt(9)
    v_mfma_f32_16x16x32_bf16 v[104:107], v[68:71], a[40:43], v[104:107]
    v_mfma_f32_16x16x32_bf16 v[108:111], v[68:71], a[44:47], v[108:111]
    ds_read_b128 v[60:63], v249 offset:960
    s_waitcnt lgkmcnt(9)
    v_mfma_f32_16x16x32_bf16 v[104:107], v[72:75], a[48:51], v[104:107]
    v_mfma_f32_16x16x32_bf16 v[108:111], v[72:75], a[52:55], v[108:111]
    s_waitcnt lgkmcnt(8)
    v_mfma_f32_16x16x32_bf16 v[104:107], v[76:79], a[56:59], v[104:107]
    v_mfma_f32_16x16x32_bf16 v[108:111], v[76:79], a[60:63], v[108:111]
    s_waitcnt lgkmcnt(7)
    v_mfma_f32_16x16x32_bf16 v[104:107], v[80:83], a[64:67], v[104:107]
    v_mfma_f32_16x16x32_bf16 v[108:111], v[80:83], a[68:71], v[108:111]
    s_waitcnt lgkmcnt(6)
    v_mfma_f32_16x16x32_bf16 v[104:107], v[84:87], a[72:75], v[104:107]
    v_mfma_f32_16x16x32_bf16 v[108:111], v[84:87], a[76:79], v[108:111]
    s_waitcnt lgkmcnt(5)
    v_mfma_f32_16x16x32_bf16 v[104:107], v[88:91], a[80:83], v[104:107]
    v_mfma_f32_16x16x32_bf16 v[108:111], v[88:91], a[84:87], v[108:111]
    s_waitcnt lgkmcnt(4)
    v_mfma_f32_16x16x32_bf16 v[104:107], v[92:95], a[88:91], v[104:107]
    v_mfma_f32_16x16x32_bf16 v[108:111], v[92:95], a[92:95], v[108:111]
    s_waitcnt lgkmcnt(3)
    v_mfma_f32_16x16x32_bf16 v[104:107], v[48:51], a[96:99], v[104:107]
    v_mfma_f32_16x16x32_bf16 v[108:111], v[48:51], a[100:103], v[108:111]
    s_waitcnt lgkmcnt(2)
    v_mfma_f32_16x16x32_bf16 v[104:107], v[52:55], a[104:107], v[104:107]
    v_mfma_f32_16x16x32_bf16 v[108:111], v[52:55], a[108:111], v[108:111]
    s_waitcnt lgkmcnt(1)
    v_mfma_f32_16x16x32_bf16 v[104:107], v[56:59], a[112:115], v[104:107]
    v_mfma_f32_16x16x32_bf16 v[108:111], v[56:59], a[116:119], v[108:111]
    s_waitcnt lgkmcnt(0)
    v_mfma_f32_16x16x32_bf16 v[104:107], v[60:63], a[120:123], v[104:107]
    v_mfma_f32_16x16x32_bf16 v[108:111], v[60:63], a[124:127], v[108:111]
    s_nop 7
    v_mov_b32_dpp v40, v108 quad_perm:[1,0,3,2] row_mask:0xf bank_mask:0xf
    v_mov_b32_dpp v41, v104 quad_perm:[1,0,3,2] row_mask:0xf bank_mask:0xf
    v_cndmask_b32 v40, v40, v104, s[62:63]
    v_cndmask_b32 v41, v108, v41, s[62:63]
    v_cvt_pk_bf16_f32 v112, v40, v41
    v_mov_b32_dpp v40, v109 quad_perm:[1,0,3,2] row_mask:0xf bank_mask:0xf
    v_mov_b32_dpp v41, v105 quad_perm:[1,0,3,2] row_mask:0xf bank_mask:0xf
    v_cndmask_b32 v40, v40, v105, s[62:63]
    v_cndmask_b32 v41, v109, v41, s[62:63]
    v_cvt_pk_bf16_f32 v113, v40, v41
    v_mov_b32_dpp v40, v110 quad_perm:[1,0,3,2] row_mask:0xf bank_mask:0xf
    v_mov_b32_dpp v41, v106 quad_perm:[1,0,3,2] row_mask:0xf bank_mask:0xf
    v_cndmask_b32 v40, v40, v106, s[62:63]
    v_cndmask_b32 v41, v110, v41, s[62:63]
    v_cvt_pk_bf16_f32 v114, v40, v41
    v_mov_b32_dpp v40, v111 quad_perm:[1,0,3,2] row_mask:0xf bank_mask:0xf
    v_mov_b32_dpp v41, v107 quad_perm:[1,0,3,2] row_mask:0xf bank_mask:0xf
    v_cndmask_b32 v40, v40, v107, s[62:63]
    v_cndmask_b32 v41, v111, v41, s[62:63]
    v_cvt_pk_bf16_f32 v115, v40, v41
    s_waitcnt vmcnt(16)
    s_waitcnt lgkmcnt(0)
    s_barrier
    s_add_u32 m0, s32, 98304
    s_add_u32 s0, s35, 262144
    buffer_load_dwordx4 v244, s[80:83], s0 offen nt lds
    s_add_u32 m0, s32, 99328
    s_add_u32 s0, s35, 266240
    buffer_load_dwordx4 v245, s[80:83], s0 offen nt lds
    s_add_u32 m0, s32, 100352
    s_add_u32 s0, s35, 270336
    buffer_load_dwordx4 v244, s[80:83], s0 offen nt lds
    s_add_u32 m0, s32, 101376
    s_add_u32 s0, s35, 274432
    buffer_load_dwordx4 v245, s[80:83], s0 offen nt lds
    s_add_u32 m0, s32, 102400
    s_add_u32 s0, s35, 278528
    buffer_load_dwordx4 v244, s[80:83], s0 offen nt lds
    s_add_u32 m0, s32, 103424
    s_add_u32 s0, s35, 282624
    buffer_load_dwordx4 v245, s[80:83], s0 offen nt lds
    s_add_u32 m0, s32, 104448
    s_add_u32 s0, s35, 286720
    buffer_load_dwordx4 v244, s[80:83], s0 offen nt lds
    s_add_u32 m0, s32, 105472
    s_add_u32 s0, s35, 290816
    buffer_load_dwordx4 v245, s[80:83], s0 offen nt lds
    s_waitcnt vmcnt(16)
    s_waitcnt lgkmcnt(0)
    s_barrier
    v_and_b32 v130, 7, v1
    v_lshlrev_b32 v130, 5, v130
    buffer_load_dwordx2 v[128:129], v130, s[20:23], 0 offen sc1
    v_add_u32 v124, 32768, v7
    v_xor_b32 v125, 128, v124
    v_xor_b32 v126, 32, v124
    v_xor_b32 v127, 160, v124
    ds_read_b64_tr_b16 a[128:129], v124 offset:0
    ds_read_b64_tr_b16 a[130:131], v125 offset:1024
    ds_read_b64_tr_b16 a[132:133], v126 offset:0
    ds_read_b64_tr_b16 a[134:135], v127 offset:1024
    ds_read_b64_tr_b16 a[136:137], v124 offset:8192
    ds_read_b64_tr_b16 a[138:139], v125 offset:9216
    ds_read_b64_tr_b16 a[140:141], v126 offset:8192
    ds_read_b64_tr_b16 a[142:143], v127 offset:9216
    ds_read_b64_tr_b16 a[144:145], v124 offset:16384
    ds_read_b64_tr_b16 a[146:147], v125 offset:17408
    ds_read_b64_tr_b16 a[148:149], v126 offset:16384
    ds_read_b64_tr_b16 a[150:151], v127 offset:17408
    ds_read_b64_tr_b16 a[152:153], v124 offset:24576
    ds_read_b64_tr_b16 a[154:155], v125 offset:25600
    ds_read_b64_tr_b16 a[156:157], v126 offset:24576
    ds_read_b64_tr_b16 a[158:159], v127 offset:25600
    s_waitcnt vmcnt(9)
    s_waitcnt lgkmcnt(0)
    s_barrier
    s_add_u32 m0, s32, 32768
    s_add_u32 s0, s35, 393216
    buffer_load_dwordx4 v244, s[80:83], s0 offen nt lds
    s_add_u32 m0, s32, 33792
    s_add_u32 s0, s35, 397312
    buffer_load_dwordx4 v245, s[80:83], s0 offen nt lds
    s_add_u32 m0, s32, 34816
    s_add_u32 s0, s35, 401408
    buffer_load_dwordx4 v244, s[80:83], s0 offen nt lds
    s_add_u32 m0, s32, 35840
    s_add_u32 s0, s35, 405504
    buffer_load_dwordx4 v245, s[80:83], s0 offen nt lds
    s_add_u32 m0, s32, 36864
    s_add_u32 s0, s35, 409600
    buffer_load_dwordx4 v244, s[80:83], s0 offen nt lds
    s_add_u32 m0, s32, 37888
    s_add_u32 s0, s35, 413696
    buffer_load_dwordx4 v245, s[80:83], s0 offen nt lds
    s_add_u32 m0, s32, 38912
    s_add_u32 s0, s35, 417792
    buffer_load_dwordx4 v244, s[80:83], s0 offen nt lds
    s_add_u32 m0, s32, 39936
    s_add_u32 s0, s35, 421888
    buffer_load_dwordx4 v245, s[80:83], s0 offen nt lds
    v_add_u32 v124, 65536, v7
    v_xor_b32 v125, 128, v124
    v_xor_b32 v126, 32, v124
    v_xor_b32 v127, 160, v124
    ds_read_b64_tr_b16 a[160:161], v124 offset:0
    ds_read_b64_tr_b16 a[162:163], v125 offset:1024
    ds_read_b64_tr_b16 a[164:165], v126 offset:0
    ds_read_b64_tr_b16 a[166:167], v127 offset:1024
    ds_read_b64_tr_b16 a[168:169], v124 offset:8192
    ds_read_b64_tr_b16 a[170:171], v125 offset:9216
    ds_read_b64_tr_b16 a[172:173], v126 offset:8192
    ds_read_b64_tr_b16 a[174:175], v127 offset:9216
    ds_read_b64_tr_b16 a[176:177], v124 offset:16384
    ds_read_b64_tr_b16 a[178:179], v125 offset:17408
    ds_read_b64_tr_b16 a[180:181], v126 offset:16384
    ds_read_b64_tr_b16 a[182:183], v127 offset:17408
    ds_read_b64_tr_b16 a[184:185], v124 offset:24576
    ds_read_b64_tr_b16 a[186:187], v125 offset:25600
    ds_read_b64_tr_b16 a[188:189], v126 offset:24576
    ds_read_b64_tr_b16 a[190:191], v127 offset:25600
    s_waitcnt vmcnt(9)
    s_waitcnt lgkmcnt(0)
    s_barrier
    s_add_u32 m0, s32, 65536
    s_add_u32 s0, s36, 0
    buffer_load_dwordx4 v246, s[84:87], s0 offen nt lds
    s_add_u32 m0, s32, 66560
    s_add_u32 s0, s36, 28672
    buffer_load_dwordx4 v246, s[84:87], s0 offen nt lds
    s_add_u32 m0, s32, 67584
    s_add_u32 s0, s36, 57344
    buffer_load_dwordx4 v246, s[84:87], s0 offen nt lds
    s_add_u32 m0, s32, 68608
    s_add_u32 s0, s36, 86016
    buffer_load_dwordx4 v246, s[84:87], s0 offen nt lds
    s_add_u32 m0, s32, 69632
    s_add_u32 s0, s36, 114688
    buffer_load_dwordx4 v246, s[84:87], s0 offen nt lds
    s_add_u32 m0, s32, 70656
    s_add_u32 s0, s36, 143360
    buffer_load_dwordx4 v246, s[84:87], s0 offen nt lds
    s_add_u32 m0, s32, 71680
    s_add_u32 s0, s36, 172032
    buffer_load_dwordx4 v246, s[84:87], s0 offen nt lds
    s_add_u32 m0, s32, 72704
    s_add_u32 s0, s36, 200704
    buffer_load_dwordx4 v246, s[84:87], s0 offen nt lds
    v_add_u32 v124, 98304, v7
    v_xor_b32 v125, 128, v124
    v_xor_b32 v126, 32, v124
    v_xor_b32 v127, 160, v124
    ds_read_b64_tr_b16 a[192:193], v124 offset:0
    ds_read_b64_tr_b16 a[194:195], v125 offset:1024
    ds_read_b64_tr_b16 a[196:197], v126 offset:0
    ds_read_b64_tr_b16 a[198:199], v127 offset:1024
    ds_read_b64_tr_b16 a[200:201], v124 offset:8192
    ds_read_b64_tr_b16 a[202:203], v125 offset:9216
    ds_read_b64_tr_b16 a[204:205], v126 offset:8192
    ds_read_b64_tr_b16 a[206:207], v127 offset:9216
    ds_read_b64_tr_b16 a[208:209], v124 offset:16384
    ds_read_b64_tr_b16 a[210:211], v125 offset:17408
    ds_read_b64_tr_b16 a[212:213], v126 offset:16384
    ds_read_b64_tr_b16 a[214:215], v127 offset:17408
    ds_read_b64_tr_b16 a[216:217], v124 offset:24576
    ds_read_b64_tr_b16 a[218:219], v125 offset:25600
    ds_read_b64_tr_b16 a[220:221], v126 offset:24576
    ds_read_b64_tr_b16 a[222:223], v127 offset:25600
    s_waitcnt vmcnt(16)
    s_branch Lw_24
Lw_23:
    s_sub_u32 s66, s66, 1
    s_cbranch_scc1 L_end
    s_sleep 8
    buffer_load_dwordx2 v[128:129], v130, s[20:23], 0 offen sc1
    s_waitcnt vmcnt(0)
Lw_24:
    v_lshrrev_b32 v131, 16, v129
    v_cmp_ne_u32 vcc, 32, v131
    s_nop 0
    s_cbranch_vccnz Lw_23
    v_readlane_b32 s68, v128, s25
    v_readlane_b32 s69, v129, s25
    s_lshl_b64 s[72:73], s[72:73], 5
    s_cmp_eq_u64 s[68:69], s[72:73]
    s_cselect_b64 s[4:5], -1, 0
    s_mov_b32 s67, 0
    s_mov_b32 s68, 1024
    s_mov_b32 s69, 2048
    s_mov_b32 s70, 3072
    s_mov_b32 vcc_lo, -1
    s_mov_b32 vcc_hi, 0
    s_mov_b64 exec, vcc
    s_cmp_eq_u32 s4, 0
    s_cbranch_scc1 Lg_25
    buffer_store_dword v112, v252, s[16:19], s67 offen
    buffer_store_dword v113, v252, s[16:19], s68 offen
    buffer_store_dword v114, v252, s[16:19], s69 offen
    buffer_store_dword v115, v252, s[16:19], s70 offen
Lb_26:
    s_mov_b64 exec, -1
    s_waitcnt vmcnt(8)
    s_waitcnt lgkmcnt(0)
    s_barrier
    s_add_u32 m0, s32, 98304
    s_add_u32 s0, s36, 917504
    buffer_load_dwordx4 v246, s[84:87], s0 offen nt lds
    s_add_u32 m0, s32, 99328
    s_add_u32 s0, s36, 946176
    buffer_load_dwordx4 v246, s[84:87], s0 offen nt lds
    s_add_u32 m0, s32, 100352
    s_add_u32 s0, s36, 974848
    buffer_load_dwordx4 v246, s[84:87], s0 offen nt lds
    s_add_u32 m0, s32, 101376
    s_add_u32 s0, s36, 1003520
    buffer_load_dwordx4 v246, s[84:87], s0 offen nt lds
    s_add_u32 m0, s32, 102400
    s_add_u32 s0, s36, 1032192
    buffer_load_dwordx4 v246, s[84:87], s0 offen nt lds
    s_add_u32 m0, s32, 103424
    s_add_u32 s0, s36, 1060864
    buffer_load_dwordx4 v246, s[84:87], s0 offen nt lds
    s_add_u32 m0, s32, 104448
    s_add_u32 s0, s36, 1089536
    buffer_load_dwordx4 v246, s[84:87], s0 offen nt lds
    s_add_u32 m0, s32, 105472
    s_add_u32 s0, s36, 1118208
    buffer_load_dwordx4 v246, s[84:87], s0 offen nt lds
    v_add_u32 v124, 32768, v7
    v_xor_b32 v125, 128, v124
    v_xor_b32 v126, 32, v124
    v_xor_b32 v127, 160, v124
    ds_read_b64_tr_b16 a[224:225], v124 offset:0
    ds_read_b64_tr_b16 a[226:227], v125 offset:1024
    ds_read_b64_tr_b16 a[228:229], v126 offset:0
    ds_read_b64_tr_b16 a[230:231], v127 offset:1024
    ds_read_b64_tr_b16 a[232:233], v124 offset:8192
    ds_read_b64_tr_b16 a[234:235], v125 offset:9216
    ds_read_b64_tr_b16 a[236:237], v126 offset:8192
    ds_read_b64_tr_b16 a[238:239], v127 offset:9216
    ds_read_b64_tr_b16 a[240:241], v124 offset:16384
    ds_read_b64_tr_b16 a[242:243], v125 offset:17408
    ds_read_b64_tr_b16 a[244:245], v126 offset:16384
    ds_read_b64_tr_b16 a[246:247], v127 offset:17408
    ds_read_b64_tr_b16 a[248:249], v124 offset:24576
    ds_read_b64_tr_b16 a[250:251], v125 offset:25600
    ds_read_b64_tr_b16 a[252:253], v126 offset:24576
    ds_read_b64_tr_b16 a[254:255], v127 offset:25600
    s_waitcnt vmcnt(8)
    s_waitcnt lgkmcnt(0)
    s_barrier
    s_lshl_b32 s65, s24, 10
    buffer_load_dwordx4 v[16:19], v13, s[16:19], s65 offen offset:0 sc1
    buffer_load_dwordx4 v[20:23], v13, s[16:19], s65 offen offset:64 sc1
    buffer_load_dwordx4 v[24:27], v13, s[16:19], s65 offen offset:128 sc1
    buffer_load_dwordx4 v[28:31], v13, s[16:19], s65 offen offset:192 sc1
    s_add_u32 m0, s32, 32768
    s_add_u32 s0, s37, 0
    buffer_load_dwordx4 v244, s[88:91], s0 offen nt lds
    s_add_u32 m0, s32, 33792
    s_add_u32 s0, s37, 4096
    buffer_load_dwordx4 v245, s[88:91], s0 offen nt lds
    s_add_u32 m0, s32, 34816
    s_add_u32 s0, s37, 8192
    buffer_load_dwordx4 v244, s[88:91], s0 offen nt lds
    s_add_u32 m0, s32, 35840
    s_add_u32 s0, s37, 12288
    buffer_load_dwordx4 v245, s[88:91], s0 offen nt lds
    s_add_u32 m0, s32, 36864
    s_add_u32 s0, s37, 16384
    buffer_load_dwordx4 v244, s[88:91], s0 offen nt lds
    s_add_u32 m0, s32, 37888
    s_add_u32 s0, s37, 20480
    buffer_load_dwordx4 v245, s[88:91], s0 offen nt lds
    s_add_u32 m0, s32, 38912
    s_add_u32 s0, s37, 24576
    buffer_load_dwordx4 v244, s[88:91], s0 offen nt lds
    s_add_u32 m0, s32, 39936
    s_add_u32 s0, s37, 28672
    buffer_load_dwordx4 v245, s[88:91], s0 offen nt lds
    v_add_u32 v124, 65536, v247
    ds_read_b64_tr_b16 v[136:137], v124 offset:0
    ds_read_b64_tr_b16 v[138:139], v124 offset:512
    ds_read_b64_tr_b16 v[140:141], v124 offset:4096
    ds_read_b64_tr_b16 v[142:143], v124 offset:4608
    ds_read_b64_tr_b16 v[144:145], v124 offset:8192
    ds_read_b64_tr_b16 v[146:147], v124 offset:8704
    ds_read_b64_tr_b16 v[148:149], v124 offset:12288
    ds_read_b64_tr_b16 v[150:151], v124 offset:12800
    ds_read_b64_tr_b16 v[152:153], v124 offset:16384
    ds_read_b64_tr_b16 v[154:155], v124 offset:16896
    ds_read_b64_tr_b16 v[156:157], v124 offset:20480
    ds_read_b64_tr_b16 v[158:159], v124 offset:20992
    ds_read_b64_tr_b16 v[160:161], v124 offset:24576
    ds_read_b64_tr_b16 v[162:163], v124 offset:25088
    ds_read_b64_tr_b16 v[164:165], v124 offset:28672
    ds_read_b64_tr_b16 v[166:167], v124 offset:29184
    s_waitcnt vmcnt(12)
    s_waitcnt lgkmcnt(0)
    s_barrier
    s_add_u32 m0, s32, 65536
    s_add_u32 s0, s37, 131072
    buffer_load_dwordx4 v244, s[88:91], s0 offen nt lds
    s_add_u32 m0, s32, 66560
    s_add_u32 s0, s37, 135168
    buffer_load_dwordx4 v245, s[88:91], s0 offen nt lds
    s_add_u32 m0, s32, 67584
    s_add_u32 s0, s37, 139264
    buffer_load_dwordx4 v244, s[88:91], s0 offen nt lds
    s_add_u32 m0, s32, 68608
    s_add_u32 s0, s37, 143360
    buffer_load_dwordx4 v245, s[88:91], s0 offen nt lds
    s_add_u32 m0, s32, 69632
    s_add_u32 s0, s37, 147456
    buffer_load_dwordx4 v244, s[88:91], s0 offen nt lds
    s_add_u32 m0, s32, 70656
    s_add_u32 s0, s37, 151552
    buffer_load_dwordx4 v245, s[88:91], s0 offen nt lds
    s_add_u32 m0, s32, 71680
    s_add_u32 s0, s37, 155648
    buffer_load_dwordx4 v244, s[88:91], s0 offen nt lds
    s_add_u32 m0, s32, 72704
    s_add_u32 s0, s37, 159744
    buffer_load_dwordx4 v245, s[88:91], s0 offen nt lds
    v_add_u32 v124, 98304, v247
    ds_read_b64_tr_b16 v[168:169], v124 offset:0
    ds_read_b64_tr_b16 v[170:171], v124 offset:512
    ds_read_b64_tr_b16 v[172:173], v124 offset:4096
    ds_read_b64_tr_b16 v[174:175], v124 offset:4608
    ds_read_b64_tr_b16 v[176:177], v124 offset:8192
    ds_read_b64_tr_b16 v[178:179], v124 offset:8704
    ds_read_b64_tr_b16 v[180:181], v124 offset:12288
    ds_read_b64_tr_b16 v[182:183], v124 offset:12800
    ds_read_b64_tr_b16 v[184:185], v124 offset:16384
    ds_read_b64_tr_b16 v[186:187], v124 offset:16896
    ds_read_b64_tr_b16 v[188:189], v124 offset:20480
    ds_read_b64_tr_b16 v[190:191], v124 offset:20992
    ds_read_b64_tr_b16 v[192:193], v124 offset:24576
    ds_read_b64_tr_b16 v[194:195], v124 offset:25088
    ds_read_b64_tr_b16 v[196:197], v124 offset:28672
    ds_read_b64_tr_b16 v[198:199], v124 offset:29184
    s_waitcnt vmcnt(8)
    s_waitcnt lgkmcnt(0)
    s_barrier
    s_waitcnt vmcnt(16)
    s_mul_i32 s3, s24, 17
    s_cmp_lt_u32 s24, 2
    s_cselect_b32 s3, s3, -1
    s_call_b64 s[30:31], L_xattp
    s_add_u32 s0, s27, 100663296
    s_add_u32 m0, s1, 98304
    s_nop 0
    buffer_load_dwordx4 v132, s[8:11], s0 offen nt lds
    buffer_load_dwordx4 v133, s[8:11], s0 offen offset:1024 nt lds
    s_add_u32 m0, s1, 106496
    s_nop 0
    buffer_load_dwordx4 v132, s[12:15], s0 offen nt lds
    buffer_load_dwordx4 v133, s[12:15], s0 offen offset:1024 nt lds
    s_add_u32 s0, s27, 117440512
    s_add_u32 m0, s1, 114688
    s_nop 0
    buffer_load_dwordx4 v132, s[8:11], s0 offen nt lds
    buffer_load_dwordx4 v133, s[8:11], s0 offen offset:1024 nt lds
    s_add_u32 m0, s1, 122880
    s_nop 0
    buffer_load_dwordx4 v132, s[12:15], s0 offen nt lds
    buffer_load_dwordx4 v133, s[12:15], s0 offen offset:1024 nt lds
    v_add_u32 v124, 32768, v7
    v_xor_b32 v125, 128, v124
    v_xor_b32 v126, 32, v124
    v_xor_b32 v127, 160, v124
    ds_read_b64_tr_b16 v[200:201], v124 offset:0
    ds_read_b64_tr_b16 v[202:203], v125 offset:1024
    ds_read_b64_tr_b16 v[204:205], v126 offset:0
    ds_read_b64_tr_b16 v[206:207], v127 offset:1024
    ds_read_b64_tr_b16 v[208:209], v124 offset:8192
    ds_read_b64_tr_b16 v[210:211], v125 offset:9216
    ds_read_b64_tr_b16 v[212:213], v126 offset:8192
    ds_read_b64_tr_b16 v[214:215], v127 offset:9216
    ds_read_b64_tr_b16 v[216:217], v124 offset:16384
    ds_read_b64_tr_b16 v[218:219], v125 offset:17408
    ds_read_b64_tr_b16 v[220:221], v126 offset:16384
    ds_read_b64_tr_b16 v[222:223], v127 offset:17408
    ds_read_b64_tr_b16 v[224:225], v124 offset:24576
    ds_read_b64_tr_b16 v[226:227], v125 offset:25600
    ds_read_b64_tr_b16 v[228:229], v126 offset:24576
    ds_read_b64_tr_b16 v[230:231], v127 offset:25600
    s_waitcnt vmcnt(8)
    s_waitcnt lgkmcnt(0)
    s_barrier
    s_add_u32 s0, s27, 33554432
    s_add_u32 m0, s1, 32768
    s_nop 0
    buffer_load_dwordx4 v132, s[8:11], s0 offen nt lds
    buffer_load_dwordx4 v133, s[8:11], s0 offen offset:1024 nt lds
    s_add_u32 m0, s1, 40960
    s_nop 0
    buffer_load_dwordx4 v132, s[12:15], s0 offen nt lds
    buffer_load_dwordx4 v133, s[12:15], s0 offen offset:1024 nt lds
    s_add_u32 s0, s27, 50331648
    s_add_u32 m0, s1, 49152
    s_nop 0
    buffer_load_dwordx4 v132, s[8:11], s0 offen nt lds
    buffer_load_dwordx4 v133, s[8:11], s0 offen offset:1024 nt lds
    s_add_u32 m0, s1, 57344
    s_nop 0
    buffer_load_dwordx4 v132, s[12:15], s0 offen nt lds
    buffer_load_dwordx4 v133, s[12:15], s0 offen offset:1024 nt lds
    v_add_u32 v124, 65536, v7
    v_xor_b32 v125, 128, v124
    v_xor_b32 v126, 32, v124
    v_xor_b32 v127, 160, v124
    ds_read_b64_tr_b16 v[232:233], v124 offset:0
    ds_read_b64_tr_b16 v[234:235], v125 offset:1024
    ds_read_b64_tr_b16 v[236:237], v126 offset:0
    ds_read_b64_tr_b16 v[238:239], v127 offset:1024
    ds_read_b64_tr_b16 v[240:241], v124 offset:8192
    ds_read_b64_tr_b16 v[242:243], v125 offset:9216
    ds_read_b64_tr_b16 v[244:245], v126 offset:8192
    ds_read_b64_tr_b16 v[246:247], v127 offset:9216
    ds_read_b64_tr_b16 v[248:249], v124 offset:16384
    ds_read_b64_tr_b16 v[250:251], v125 offset:17408
    ds_read_b64_tr_b16 v[252:253], v126 offset:16384
    ds_read_b64_tr_b16 v[254:255], v127 offset:17408
    s_waitcnt lgkmcnt(0)
    s_barrier
    s_add_u32 s0, s27, 67108864
    s_add_u32 m0, s1, 65536
    s_nop 0
    buffer_load_dwordx4 v132, s[8:11], s0 offen nt lds
    buffer_load_dwordx4 v133, s[8:11], s0 offen offset:1024 nt lds
    s_add_u32 m0, s1, 73728
    s_nop 0
    buffer_load_dwordx4 v132, s[12:15], s0 offen nt lds
    buffer_load_dwordx4 v133, s[12:15], s0 offen offset:1024 nt lds
    s_add_u32 s0, s27, 83886080
    s_add_u32 m0, s1, 81920
    s_nop 0
    buffer_load_dwordx4 v132, s[8:11], s0 offen nt lds
    buffer_load_dwordx4 v133, s[8:11], s0 offen offset:1024 nt lds
    s_add_u32 m0, s1, 90112
    s_nop 0
    buffer_load_dwordx4 v132, s[12:15], s0 offen nt lds
    buffer_load_dwordx4 v133, s[12:15], s0 offen offset:1024 nt lds
    v_mov_b32 v48, 0x3f803f80
    v_mov_b32 v49, 0x3f803f80
    v_mov_b32 v50, 0x3f803f80
    v_mov_b32 v51, 0x3f803f80
    s_nop 1
    v_mfma_f32_16x16x32_bf16 v[52:55], v[48:51], a[0:3], 0
    v_mfma_f32_16x16x32_bf16 v[56:59], v[48:51], a[4:7], 0
    v_mfma_f32_16x16x32_bf16 v[60:63], v[48:51], v[136:139], 0
    v_mfma_f32_16x16x32_bf16 v[52:55], v[48:51], a[8:11], v[52:55]
    v_mfma_f32_16x16x32_bf16 v[56:59], v[48:51], a[12:15], v[56:59]
    v_mfma_f32_16x16x32_bf16 v[60:63], v[48:51], v[140:143], v[60:63]
    v_mfma_f32_16x16x32_bf16 v[52:55], v[48:51], a[16:19], v[52:55]
    v_mfma_f32_16x16x32_bf16 v[56:59], v[48:51], a[20:23], v[56:59]
    v_mfma_f32_16x16x32_bf16 v[60:63], v[48:51], v[144:147], v[60:63]
    v_mfma_f32_16x16x32_bf16 v[52:55], v[48:51], a[24:27], v[52:55]
    v_mfma_f32_16x16x32_bf16 v[56:59], v[48:51], a[28:31], v[56:59]
    v_mfma_f32_16x16x32_bf16 v[60:63], v[48:51], v[148:151], v[60:63]
    v_mfma_f32_16x16x32_bf16 v[52:55], v[48:51], a[32:35], v[52:55]
    v_mfma_f32_16x16x32_bf16 v[56:59], v[48:51], a[36:39], v[56:59]
    v_mfma_f32_16x16x32_bf16 v[60:63], v[48:51], v[152:155], v[60:63]
    v_mfma_f32_16x16x32_bf16 v[52:55], v[48:51], a[40:43], v[52:55]
    v_mfma_f32_16x16x32_bf16 v[56:59], v[48:51], a[44:47], v[56:59]
    v_mfma_f32_16x16x32_bf16 v[60:63], v[48:51], v[156:159], v[60:63]
    v_mfma_f32_16x16x32_bf16 v[52:55], v[48:51], a[48:51], v[52:55]
    v_mfma_f32_16x16x32_bf16 v[56:59], v[48:51], a[52:55], v[56:59]
    v_mfma_f32_16x16x32_bf16 v[60:63], v[48:51], v[160:163], v[60:63]
    v_mfma_f32_16x16x32_bf16 v[52:55], v[48:51], a[56:59], v[52:55]
    v_mfma_f32_16x16x32_bf16 v[56:59], v[48:51], a[60:63], v[56:59]
    v_mfma_f32_16x16x32_bf16 v[60:63], v[48:51], v[164:167], v[60:63]
    v_mfma_f32_16x16x32_bf16 v[52:55], v[48:51], a[64:67], v[52:55]
    v_mfma_f32_16x16x32_bf16 v[56:59], v[48:51], a[68:71], v[56:59]
    v_mfma_f32_16x16x32_bf16 v[60:63], v[48:51], v[168:171], v[60:63]
    v_mfma_f32_16x16x32_bf16 v[52:55], v[48:51], a[72:75], v[52:55]
    v_mfma_f32_16x16x32_bf16 v[56:59], v[48:51], a[76:79], v[56:59]
    v_mfma_f32_16x16x32_bf16 v[60:63], v[48:51], v[172:175], v[60:63]
    v_mfma_f32_16x16x32_bf16 v[52:55], v[48:51], a[80:83], v[52:55]
    v_mfma_f32_16x16x32_bf16 v[56:59], v[48:51], a[84:87], v[56:59]
    v_mfma_f32_16x16x32_bf16 v[60:63], v[48:51], v[176:179], v[60:63]
    v_mfma_f32_16x16x32_bf16 v[52:55], v[48:51], a[88:91], v[52:55]
    v_mfma_f32_16x16x32_bf16 v[56:59], v[48:51], a[92:95], v[56:59]
    v_mfma_f32_16x16x32_bf16 v[60:63], v[48:51], v[180:183], v[60:63]
    v_mfma_f32_16x16x32_bf16 v[52:55], v[48:51], a[96:99], v[52:55]
    v_mfma_f32_16x16x32_bf16 v[56:59], v[48:51], a[100:103], v[56:59]
    v_mfma_f32_16x16x32_bf16 v[60:63], v[48:51], v[184:187], v[60:63]
    v_mfma_f32_16x16x32_bf16 v[52:55], v[48:51], a[104:107], v[52:55]
    v_mfma_f32_16x16x32_bf16 v[56:59], v[48:51], a[108:111], v[56:59]
    v_mfma_f32_16x16x32_bf16 v[60:63], v[48:51], v[188:191], v[60:63]
    v_mfma_f32_16x16x32_bf16 v[52:55], v[48:51], a[112:115], v[52:55]
    v_mfma_f32_16x16x32_bf16 v[56:59], v[48:51], a[116:119], v[56:59]
    v_mfma_f32_16x16x32_bf16 v[60:63], v[48:51], v[192:195], v[60:63]
    v_mfma_f32_16x16x32_bf16 v[52:55], v[48:51], a[120:123], v[52:55]
    v_mfma_f32_16x16x32_bf16 v[56:59], v[48:51], a[124:127], v[56:59]
    v_mfma_f32_16x16x32_bf16 v[60:63], v[48:51], v[196:199], v[60:63]
    s_nop 5
    v_mov_b32 v120, v52
    v_mov_b32 v121, v56
    v_mov_b32 v122, v60
    v_mov_b32 v40, 0x3f80
    s_mov_b32 exec_lo, 0xf0f0f0f0
    s_mov_b32 exec_hi, 0xf0f0f0f0
    v_mov_b32 v40, 0x3f800000
    s_mov_b64 exec, -1
    v_mov_b32 v132, 0
    v_mov_b32 v133, 0
    v_mov_b32 v134, 0
    v_mov_b32 v135, 0
    s_mov_b32 exec_lo, 0x11111111
    s_mov_b32 exec_hi, 0x11111111
    v_mov_b32 v132, v40
    s_mov_b32 exec_lo, 0x22222222
    s_mov_b32 exec_hi, 0x22222222
    v_mov_b32 v133, v40
    s_mov_b32 exec_lo, 0x44444444
    s_mov_b32 exec_hi, 0x44444444
    v_mov_b32 v134, v40
    s_mov_b32 exec_lo, 0x88888888
    s_mov_b32 exec_hi, 0x88888888
    v_mov_b32 v135, v40
    s_mov_b64 exec, -1
    s_mov_b32 s0, 0x000f000f
    s_mov_b32 s1, 0x000f000f
    s_mov_b32 s60, 0xf0f0f0f0
    s_mov_b32 s61, 0xf0f0f0f0
    s_cmp_eq_u32 s71, 0
    s_cselect_b32 s55, s25, 99
    s_lshl_b32 s67, s71, 2
    s_add_u32 s67, s67, s24
    s_cmp_lt_u32 s67, 14
    s_cselect_b64 s[100:101], s[62:63], 0
    s_mov_b32 s42, 0x00003f80
    s_mov_b32 s43, 0x3f800000
    s_mov_b32 s40, 180224
    s_mov_b32 s37, 0
    s_mov_b32 s32, 0
    s_mov_b32 s37, 1
    s_mov_b32 s33, 0
    s_mov_b32 s34, 8192
    s_mov_b32 s35, 8192
    s_mov_b32 s36, 8192
    s_mov_b32 s40, 0
    s_mov_b32 s41, 16384
    s_mov_b32 s44, 0xffffffff
    s_mov_b32 s45, 0xffffffff
    s_mov_b32 s46, 0xffff
    s_mov_b32 s47, 0x0
    s_and_b64 s[46:47], s[100:101], s[46:47]
    s_mov_b32 s48, 0xffff
    s_mov_b32 s49, 0x0
    s_mov_b32 s54, 8192
    s_mov_b32 s50, 0
    s_mov_b32 s51, s50
    s_mov_b32 s52, 0
    s_mov_b32 s53, s52
    s_call_b64 s[74:75], L_seg0
    s_waitcnt vmcnt(0)
    s_barrier
    s_lshl_b32 s67, s24, 3
    s_or_b32 s67, s67, 0x80000
    s_bfe_u32 s3, 0x55443322, s67
    s_and_b32 s65, s3, 15
    s_lshl_b32 s65, s65, 10
    s_mov_b32 s26, 0
    s_mov_b32 s38, 0
    s_mov_b32 s58, 0xffffffff
    s_mov_b32 s59, 0xffffffff
    s_mov_b32 s64, 44160
    s_mov_b32 s72, 44160
    s_mov_b32 s73, 27648
    s_mov_b32 s2, 27648
    s_mov_b32 exec_lo, 0xf000f
    s_mov_b32 exec_hi, 0xf000f
    v_subrev_u32 v45, 103424, v2
    s_mov_b32 exec_lo, 0xf000f0
    s_mov_b32 exec_hi, 0xf000f0
    v_subrev_u32 v45, 104512, v2
    s_mov_b32 exec_lo, 0xf000f00
    s_mov_b32 exec_hi, 0xf000f00
    v_subrev_u32 v45, 105600, v2
    s_mov_b32 exec_lo, 0xf000f000
    s_mov_b32 exec_hi, 0xf000f000
    v_subrev_u32 v45, 106688, v2
    s_mov_b64 exec, -1
    s_call_b64 s[74:75], L_seg1s
    s_waitcnt vmcnt(1)
    s_call_b64 s[30:31], L_xattp
    s_waitcnt vmcnt(0)
    s_call_b64 s[74:75], L_seg2
    v_mov_b32 v40, -1
    v_mov_b32 v41, -1
    v_mov_b32 v42, -1
    v_mov_b32 v43, -1
    s_mov_b32 s67, 44160
    s_mov_b64 exec, -1
    s_cmp_eq_u32 s4, 0
    s_cbranch_scc1 Lg_27
    buffer_store_dwordx4 v[40:43], v123, s[16:19], s67 offen offset:0
    buffer_store_dwordx4 v[40:43], v123, s[16:19], s67 offen offset:1024
    buffer_store_dwordx4 v[40:43], v123, s[16:19], s67 offen offset:1280
Lb_28:
    s_mov_b64 exec, -1
    s_movk_i32 s3, 0xff
    s_mov_b32 s26, 1
    s_mov_b32 s38, 49152
    s_mov_b32 s58, 0xffffffff
    s_mov_b32 s59, 0x0
    s_mov_b32 s64, 81024
    s_mov_b32 s72, 81024
    s_mov_b32 s73, 28672
    s_mov_b32 s2, 28672
    s_mov_b32 exec_lo, 0xf000f
    s_mov_b32 exec_hi, 0xf000f
    v_subrev_u32 v45, 102400, v2
    s_mov_b32 exec_lo, 0xf000f0
    s_mov_b32 exec_hi, 0xf000f0
    v_subrev_u32 v45, 103488, v2
    s_mov_b32 exec_lo, 0xf000f00
    s_mov_b32 exec_hi, 0xf000f00
    v_subrev_u32 v45, 104576, v2
    s_mov_b32 exec_lo, 0xf000f000
    s_mov_b32 exec_hi, 0xf000f000
    v_subrev_u32 v45, 105664, v2
    s_mov_b64 exec, -1
    s_call_b64 s[74:75], L_seg1s
    s_mov_b32 s26, 1
    s_waitcnt vmcnt(1)
    s_call_b64 s[74:75], L_seg3s
    s_mov_b32 s32, 0
    s_mov_b32 s37, 0
    s_mov_b32 s33, 1024
    s_mov_b32 s34, 8192
    s_mov_b32 s35, 8192
    s_mov_b32 s36, 8192
    s_mov_b32 s40, 49152
    s_mov_b32 s41, 19456
    s_mov_b32 s44, 0xffffffff
    s_mov_b32 s45, 0x0
    s_mov_b32 s46, 0xffff
    s_mov_b32 s47, 0x0
    s_and_b64 s[46:47], s[100:101], s[46:47]
    s_mov_b32 s48, 0xffff
    s_mov_b32 s49, 0x0
    s_mov_b32 s54, 9216
    s_mov_b32 s50, 0
    s_mov_b32 s51, s50
    s_mov_b32 s52, 0
    s_mov_b32 s53, s52
    s_call_b64 s[74:75], L_seg0
    s_waitcnt vmcnt(1)
    s_call_b64 s[74:75], L_seg2s
    v_mov_b32 v40, -1
    v_mov_b32 v41, -1
    v_mov_b32 v42, -1
    v_mov_b32 v43, -1
    s_mov_b32 s67, 81024
    s_mov_b64 exec, -1
    s_cmp_eq_u32 s4, 0
    s_cbranch_scc1 Lg_29
    buffer_store_dwordx4 v[40:43], v123, s[16:19], s67 offen offset:0
    buffer_store_dwordx4 v[40:43], v123, s[16:19], s67 offen offset:1024
    buffer_store_dwordx4 v[40:43], v123, s[16:19], s67 offen offset:1280
Lb_30:
    s_mov_b64 exec, -1
    s_lshl_b32 s67, s24, 3
    s_or_b32 s67, s67, 0x80000
    s_bfe_u32 s3, 0xff087766, s67
    s_and_b32 s65, s3, 15
    s_lshl_b32 s65, s65, 10
    s_mov_b32 s26, 1
    s_mov_b32 s38, 32768
    s_mov_b32 s58, 0xffffffff
    s_mov_b32 s59, 0x0
    s_mov_b32 s64, 117888
    s_mov_b32 s72, 117888
    s_mov_b32 s73, 29696
    s_mov_b32 s2, 29696
    s_mov_b32 exec_lo, 0xf000f
    s_mov_b32 exec_hi, 0xf000f
    v_subrev_u32 v45, 101376, v2
    s_mov_b32 exec_lo, 0xf000f0
    s_mov_b32 exec_hi, 0xf000f0
    v_subrev_u32 v45, 102464, v2
    s_mov_b32 exec_lo, 0xf000f00
    s_mov_b32 exec_hi, 0xf000f00
    v_subrev_u32 v45, 103552, v2
    s_mov_b32 exec_lo, 0xf000f000
    s_mov_b32 exec_hi, 0xf000f000
    v_subrev_u32 v45, 104640, v2
    s_mov_b64 exec, -1
    s_call_b64 s[74:75], L_seg1s
    s_waitcnt vmcnt(5)
    s_call_b64 s[30:31], L_xattp
    s_mov_b32 s26, 1
    s_waitcnt vmcnt(1)
    s_call_b64 s[74:75], L_seg3s
    s_mov_b32 s32, 0
    s_mov_b32 s37, 0
    s_mov_b32 s33, 2048
    s_mov_b32 s34, 8192
    s_mov_b32 s35, 8192
    s_mov_b32 s36, 8192
    s_mov_b32 s40, 32768
    s_mov_b32 s41, 18432
    s_mov_b32 s44, 0xffffffff
    s_mov_b32 s45, 0x0
    s_mov_b32 s46, 0xffff
    s_mov_b32 s47, 0x0
    s_and_b64 s[46:47], s[100:101], s[46:47]
    s_mov_b32 s48, 0xffff
    s_mov_b32 s49, 0x0
    s_mov_b32 s54, 10240
    s_mov_b32 s50, 0
    s_mov_b32 s51, s50
    s_mov_b32 s52, 0
    s_mov_b32 s53, s52
    s_call_b64 s[74:75], L_seg0
    s_waitcnt vmcnt(1)
    s_call_b64 s[74:75], L_seg2s
    v_mov_b32 v40, -1
    v_mov_b32 v41, -1
    v_mov_b32 v42, -1
    v_mov_b32 v43, -1
    s_mov_b32 s67, 117888
    s_mov_b64 exec, -1
    s_cmp_eq_u32 s4, 0
    s_cbranch_scc1 Lg_31
    buffer_store_dwordx4 v[40:43], v123, s[16:19], s67 offen offset:0
    buffer_store_dwordx4 v[40:43], v123, s[16:19], s67 offen offset:1024
    buffer_store_dwordx4 v[40:43], v123, s[16:19], s67 offen offset:1280
Lb_32:
    s_mov_b64 exec, -1
    s_lshl_b32 s67, s24, 3
    s_or_b32 s67, s67, 0x80000
    s_bfe_u32 s3, 0xffffff19, s67
    s_and_b32 s65, s3, 15
    s_lshl_b32 s65, s65, 10
    s_mov_b32 s26, 1
    s_mov_b32 s38, 65536
    s_mov_b32 s58, 0xffffffff
    s_mov_b32 s59, 0x0
    s_mov_b32 s64, 154752
    s_mov_b32 s72, 44160
    s_mov_b32 s73, 30720
    s_mov_b32 s2, 35840
    s_mov_b32 exec_lo, 0xf000f
    s_mov_b32 exec_hi, 0xf000f
    v_subrev_u32 v45, 100352, v2
    s_mov_b32 exec_lo, 0xf000f0
    s_mov_b32 exec_hi, 0xf000f0
    v_subrev_u32 v45, 96320, v2
    s_mov_b32 exec_lo, 0xf000f00
    s_mov_b32 exec_hi, 0xf000f00
    v_subrev_u32 v45, 102528, v2
    s_mov_b32 exec_lo, 0xf000f000
    s_mov_b32 exec_hi, 0xf000f000
    v_subrev_u32 v45, 103616, v2
    s_mov_b64 exec, -1
    s_call_b64 s[74:75], L_seg1
    s_waitcnt vmcnt(5)
    s_call_b64 s[30:31], L_xattp
    s_mov_b32 s26, 1
    s_waitcnt vmcnt(1)
    s_call_b64 s[74:75], L_seg3s
    s_mov_b32 s32, 1
    s_mov_b32 s37, 0
    s_mov_b32 s33, 3072
    s_mov_b32 s34, 0
    s_mov_b32 s35, 8192
    s_mov_b32 s36, 8192
    s_mov_b32 s40, 65536
    s_mov_b32 s41, 20480
    s_mov_b32 s44, 0xffffffff
    s_mov_b32 s45, 0x0
    s_mov_b32 s46, 0xffffffff
    s_mov_b32 s47, 0x0
    s_and_b64 s[46:47], s[100:101], s[46:47]
    s_mov_b32 s48, 0xffff
    s_mov_b32 s49, 0x0
    s_mov_b32 s54, 11264
    s_mov_b32 s50, 0
    s_cmp_eq_u32 s55, 0
    s_cselect_b32 s50, 0xf0f0f0f0, s50
    s_mov_b32 s51, s50
    s_mov_b32 s52, 0
    s_mov_b32 s53, s52
    s_call_b64 s[74:75], L_seg0
    s_waitcnt vmcnt(1)
    s_call_b64 s[74:75], L_seg2s
    v_mov_b32 v40, -1
    v_mov_b32 v41, -1
    v_mov_b32 v42, -1
    v_mov_b32 v43, -1
    s_mov_b32 s67, 154752
    s_mov_b64 exec, -1
    s_cmp_eq_u32 s4, 0
    s_cbranch_scc1 Lg_33
    buffer_store_dwordx4 v[40:43], v123, s[16:19], s67 offen offset:0
    buffer_store_dwordx4 v[40:43], v123, s[16:19], s67 offen offset:1024
    buffer_store_dwordx4 v[40:43], v123, s[16:19], s67 offen offset:1280
Lb_34:
    s_mov_b64 exec, -1
    s_lshl_b32 s67, s24, 3
    s_or_b32 s67, s67, 0x80000
    s_bfe_u32 s3, 0xffffff2a, s67
    s_and_b32 s65, s3, 15
    s_lshl_b32 s65, s65, 10
    s_mov_b32 s26, 1
    s_mov_b32 s38, 81920
    s_mov_b32 s58, 0xffffffff
    s_mov_b32 s59, 0x0
    s_mov_b32 s64, 191616
    s_mov_b32 s72, 81024
    s_mov_b32 s73, 31744
    s_mov_b32 s2, 36864
    s_mov_b32 exec_lo, 0xf000f
    s_mov_b32 exec_hi, 0xf000f
    v_subrev_u32 v45, 99328, v2
    s_mov_b32 exec_lo, 0xf000f0
    s_mov_b32 exec_hi, 0xf000f0
    v_subrev_u32 v45, 95296, v2
    s_mov_b32 exec_lo, 0xf000f00
    s_mov_b32 exec_hi, 0xf000f00
    v_subrev_u32 v45, 101504, v2
    s_mov_b32 exec_lo, 0xf000f000
    s_mov_b32 exec_hi, 0xf000f000
    v_subrev_u32 v45, 102592, v2
    s_mov_b64 exec, -1
    s_call_b64 s[74:75], L_seg1
    s_waitcnt vmcnt(5)
    s_call_b64 s[30:31], L_xattp
    s_mov_b32 s26, 1
    s_waitcnt vmcnt(1)
    s_call_b64 s[74:75], L_seg3s
    s_mov_b32 s32, 1
    s_mov_b32 s37, 0
    s_mov_b32 s33, 4096
    s_mov_b32 s34, 1024
    s_mov_b32 s35, 8192
    s_mov_b32 s36, 8192
    s_mov_b32 s40, 81920
    s_mov_b32 s41, 21504
    s_mov_b32 s44, 0xffffffff
    s_mov_b32 s45, 0x0
    s_mov_b32 s46, 0xffffffff
    s_mov_b32 s47, 0x0
    s_and_b64 s[46:47], s[100:101], s[46:47]
    s_mov_b32 s48, 0xffff
    s_mov_b32 s49, 0x0
    s_mov_b32 s54, 12288
    s_mov_b32 s50, 0
    s_cmp_eq_u32 s55, 1
    s_cselect_b32 s50, 0xf0f0f0f0, s50
    s_mov_b32 s51, s50
    s_mov_b32 s52, 0
    s_mov_b32 s53, s52
    s_call_b64 s[74:75], L_seg0
    s_waitcnt vmcnt(1)
    s_call_b64 s[74:75], L_seg2s
    v_mov_b32 v40, -1
    v_mov_b32 v41, -1
    v_mov_b32 v42, -1
    v_mov_b32 v43, -1
    s_mov_b32 s67, 191616
    s_mov_b64 exec, -1
    s_cmp_eq_u32 s4, 0
    s_cbranch_scc1 Lg_35
    buffer_store_dwordx4 v[40:43], v123, s[16:19], s67 offen offset:0
    buffer_store_dwordx4 v[40:43], v123, s[16:19], s67 offen offset:1024
    buffer_store_dwordx4 v[40:43], v123, s[16:19], s67 offen offset:1280
Lb_36:
    s_mov_b64 exec, -1
    s_lshl_b32 s67, s24, 3
    s_or_b32 s67, s67, 0x80000
    s_bfe_u32 s3, 0xffffff3b, s67
    s_and_b32 s65, s3, 15
    s_lshl_b32 s65, s65, 10
    s_mov_b32 s26, 1
    s_mov_b32 s38, 98304
    s_mov_b32 s58, 0xffffffff
    s_mov_b32 s59, 0x0
    s_mov_b32 s64, 228480
    s_mov_b32 s72, 117888
    s_mov_b32 s73, 32768
    s_mov_b32 s2, 37888
    s_mov_b32 exec_lo, 0xf000f
    s_mov_b32 exec_hi, 0xf000f
    v_subrev_u32 v45, 98304, v2
    s_mov_b32 exec_lo, 0xf000f0
    s_mov_b32 exec_hi, 0xf000f0
    v_subrev_u32 v45, 94272, v2
    s_mov_b32 exec_lo, 0xf000f00
    s_mov_b32 exec_hi, 0xf000f00
    v_subrev_u32 v45, 100480, v2
    s_mov_b32 exec_lo, 0xf000f000
    s_mov_b32 exec_hi, 0xf000f000
    v_subrev_u32 v45, 101568, v2
    s_mov_b64 exec, -1
    s_call_b64 s[74:75], L_seg1
    s_waitcnt vmcnt(5)
    s_call_b64 s[30:31], L_xattp
    s_mov_b32 s26, 1
    s_waitcnt vmcnt(1)
    s_call_b64 s[74:75], L_seg3s
    s_mov_b32 s32, 1
    s_mov_b32 s37, 0
    s_mov_b32 s33, 5120
    s_mov_b32 s34, 2048
    s_mov_b32 s35, 8192
    s_mov_b32 s36, 8192
    s_mov_b32 s40, 98304
    s_mov_b32 s41, 22528
    s_mov_b32 s44, 0xffffffff
    s_mov_b32 s45, 0x0
    s_mov_b32 s46, 0xffffffff
    s_mov_b32 s47, 0x0
    s_and_b64 s[46:47], s[100:101], s[46:47]
    s_mov_b32 s48, 0xffff
    s_mov_b32 s49, 0x0
    s_mov_b32 s54, 13312
    s_mov_b32 s50, 0
    s_cmp_eq_u32 s55, 2
    s_cselect_b32 s50, 0xf0f0f0f0, s50
    s_mov_b32 s51, s50
    s_mov_b32 s52, 0
    s_mov_b32 s53, s52
    s_call_b64 s[74:75], L_seg0
    s_waitcnt vmcnt(1)
    s_call_b64 s[74:75], L_seg2s
    v_mov_b32 v40, -1
    v_mov_b32 v41, -1
    v_mov_b32 v42, -1
    v_mov_b32 v43, -1
    s_mov_b32 s67, 228480
    s_mov_b64 exec, -1
    s_cmp_eq_u32 s4, 0
    s_cbranch_scc1 Lg_37
    buffer_store_dwordx4 v[40:43], v123, s[16:19], s67 offen offset:0
    buffer_store_dwordx4 v[40:43], v123, s[16:19], s67 offen offset:1024
    buffer_store_dwordx4 v[40:43], v123, s[16:19], s67 offen offset:1280
Lb_38:
    s_mov_b64 exec, -1
    s_mov_b32 s64, 265344
    s_mov_b32 s72, 154752
    s_mov_b32 s73, 33792
    s_mov_b32 s2, 38912
    s_call_b64 s[30:31], L_dc2
    s_mov_b32 s26, 0
    s_waitcnt vmcnt(0)
    s_call_b64 s[74:75], L_seg3
    s_lshl_b32 s67, s24, 3
    s_or_b32 s67, s67, 0x80000
    s_bfe_u32 s3, 0xffff5d4c, s67
    s_call_b64 s[30:31], L_xatt
    s_mov_b32 s32, 2
    s_mov_b32 s37, 1
    s_mov_b32 s33, 6144
    s_mov_b32 s34, 7168
    s_mov_b32 s35, 3072
    s_mov_b32 s36, 8192
    s_mov_b32 s40, 114688
    s_mov_b32 s41, 23552
    s_mov_b32 s44, 0xffffffff
    s_mov_b32 s45, 0xffffffff
    s_mov_b32 s46, 0xffffffff
    s_mov_b32 s47, 0xffff
    s_and_b64 s[46:47], s[100:101], s[46:47]
    s_mov_b32 s48, 0xffffffff
    s_mov_b32 s49, 0x0
    s_mov_b32 s54, 14336
    s_mov_b32 s50, 0
    s_mov_b32 s51, s50
    s_mov_b32 s52, 0
    s_cmp_eq_u32 s55, 3
    s_cselect_b32 s52, 0xf0f0f0f, s52
    s_mov_b32 s53, s52
    s_call_b64 s[74:75], L_seg0
    s_movk_i32 s3, 0xff
    s_mov_b32 s26, 0
    s_mov_b32 s38, 114688
    s_mov_b32 s58, 0xffffffff
    s_mov_b32 s59, 0xffffffff
    s_mov_b32 s64, 302208
    s_mov_b32 s72, 302208
    s_mov_b32 s73, 34816
    s_mov_b32 s2, 34816
    s_mov_b32 exec_lo, 0xf000f
    s_mov_b32 exec_hi, 0xf000f
    v_subrev_u32 v45, 97280, v2
    s_mov_b32 exec_lo, 0xf000f0
    s_mov_b32 exec_hi, 0xf000f0
    v_subrev_u32 v45, 97344, v2
    s_mov_b32 exec_lo, 0xf000f00
    s_mov_b32 exec_hi, 0xf000f00
    v_subrev_u32 v45, 94336, v2
    s_mov_b32 exec_lo, 0xf000f000
    s_mov_b32 exec_hi, 0xf000f000
    v_subrev_u32 v45, 100544, v2
    s_mov_b64 exec, -1
    s_call_b64 s[74:75], L_seg1s
    s_waitcnt vmcnt(0)
    s_call_b64 s[74:75], L_seg2
    s_mov_b32 s37, 0
    s_mov_b32 s26, 0
    s_waitcnt vmcnt(0)
    s_call_b64 s[74:75], L_seg3
    s_lshl_b32 s67, s24, 10
    s_add_u32 s67, s67, 131072
    v_lshlrev_b32 v40, 4, v1
    v_add_u32 v40, s67, v40
    ds_write_b128 v40, v[116:119]
    s_mov_b32 s64, 191616
    s_mov_b32 s72, 228480
    s_mov_b32 s73, 39936
    s_mov_b32 s2, 40960
    s_call_b64 s[30:31], L_dc2
    s_lshl_b32 s67, s24, 3
    s_or_b32 s67, s67, 0x80000
    s_bfe_u32 s3, 0xffff9f8e, s67
    s_call_b64 s[30:31], L_xatt
    s_mov_b32 s32, 3
    s_mov_b32 s37, 1
    s_mov_b32 s33, 6144
    s_mov_b32 s34, 7168
    s_mov_b32 s35, 5120
    s_mov_b32 s36, 4096
    s_mov_b32 s40, 147456
    s_mov_b32 s41, 25600
    s_mov_b32 s44, 0xffffffff
    s_mov_b32 s45, 0xffffffff
    s_mov_b32 s46, 0xffffffff
    s_mov_b32 s47, 0xffffffff
    s_and_b64 s[46:47], s[100:101], s[46:47]
    s_mov_b32 s48, 0x0
    s_mov_b32 s49, 0x0
    s_mov_b32 s54, 14336
    s_mov_b32 s50, 0
    s_cmp_eq_u32 s55, 6
    s_cselect_b32 s50, 0xf0f0f0f, s50
    s_cmp_eq_u32 s55, 7
    s_cselect_b32 s50, 0xf0f0f0f0, s50
    s_mov_b32 s51, s50
    s_mov_b32 s52, 0
    s_cmp_eq_u32 s55, 5
    s_cselect_b32 s52, 0xf0f0f0f, s52
    s_cmp_eq_u32 s55, 4
    s_cselect_b32 s52, 0xf0f0f0f0, s52
    s_mov_b32 s53, s52
    s_call_b64 s[74:75], L_seg0
    s_movk_i32 s3, 0xff
    s_mov_b32 s26, 0
    s_mov_b32 s38, 147456
    s_mov_b32 s58, 0xffffffff
    s_mov_b32 s59, 0xffffffff
    s_mov_b32 s64, 339072
    s_mov_b32 s72, 375936
    s_mov_b32 s73, 41984
    s_mov_b32 s2, 43008
    s_mov_b32 exec_lo, 0xf000f
    s_mov_b32 exec_hi, 0xf000f
    v_subrev_u32 v45, 89088, v2
    s_mov_b32 exec_lo, 0xf000f0
    s_mov_b32 exec_hi, 0xf000f0
    v_subrev_u32 v45, 89152, v2
    s_mov_b32 exec_lo, 0xf000f00
    s_mov_b32 exec_hi, 0xf000f00
    v_subrev_u32 v45, 92288, v2
    s_mov_b32 exec_lo, 0xf000f000
    s_mov_b32 exec_hi, 0xf000f000
    v_subrev_u32 v45, 94400, v2
    s_mov_b64 exec, -1
    s_call_b64 s[74:75], L_seg1
    s_waitcnt vmcnt(0)
    s_call_b64 s[74:75], L_seg2
    s_cmp_eq_u32 s55, 3
    s_cbranch_scc1 Lo3_40
    s_or_b32 s67, s50, s52
    s_cmp_eq_u32 s67, 0
    s_cbranch_scc1 L_end
    s_cmp_eq_u32 s52, 0
    s_cbranch_scc1 Lsk_39
    s_add_u32 s40, s40, 16384
    s_mov_b64 s[50:51], s[52:53]
    s_mov_b64 s[48:49], 0
    v_mov_b32 v38, v39
    v_mov_b32 v112, v116
    v_mov_b32 v113, v117
    v_mov_b32 v114, v118
    v_mov_b32 v115, v119
    s_nop 0
    s_branch Lsk_39
Lo3_40:
    s_lshl_b32 s67, s24, 10
    s_add_u32 s67, s67, 131072
    v_lshlrev_b32 v40, 4, v1
    v_add_u32 v40, s67, v40
    ds_read_b128 v[112:115], v40
    s_mov_b32 s40, 311296
    s_mov_b32 s50, 0x0f0f0f0f
    s_mov_b32 s51, 0x0f0f0f0f
    v_add_u32 v38, 3072, v35
    s_waitcnt lgkmcnt(0)
    s_nop 0
Lsk_39:
    s_mov_b32 s37, 0
    s_mov_b32 s26, 0
    s_waitcnt vmcnt(0)
    s_call_b64 s[74:75], L_seg3
L_fin:
    s_endpgm
L_seg0:
    s_barrier
    v_add_u32 v38, s33, v35
    v_add_u32 v39, s35, v35
    s_mov_b64 exec, s[60:61]
    v_add_u32 v38, s34, v35
    v_add_u32 v39, s36, v35
    s_mov_b64 exec, -1
    v_min_u32 v41, s32, v6
    v_lshlrev_b32 v41, 9, v41
    v_lshrrev_b32 v42, 4, v1
    v_lshl_add_u32 v41, v42, 4, v41
    v_and_b32 v42, 3, v1
    v_lshl_add_u32 v10, v42, 6, v41
    v_add_u32 v42, 145216, v38
    ds_read_b64 v[44:45], v42
    s_waitcnt lgkmcnt(0)
    v_and_b32 v113, s39, v44
    v_lshlrev_b32 v112, 16, v44
    v_and_b32 v115, s39, v45
    v_lshlrev_b32 v114, 16, v45
    v_add_u32 v42, 145216, v39
    ds_read_b64 v[44:45], v42
    s_waitcnt lgkmcnt(0)
    v_and_b32 v117, s39, v44
    v_lshlrev_b32 v116, 16, v44
    v_and_b32 v119, s39, v45
    v_lshlrev_b32 v118, 16, v45
    s_nop 0
    s_setpc_b64 s[74:75]
L_seg1:
    s_call_b64 s[30:31], L_dc2
L_seg1f:
    s_waitcnt vmcnt(0)
L_seg1g:
    s_sub_u32 s66, s66, 1
    s_cbranch_scc1 L_end
    buffer_load_dwordx4 v[48:51], v45, s[16:19], 0 offen offset:0 sc1
    buffer_load_dwordx4 v[52:55], v45, s[16:19], 0 offen offset:256 sc1
    buffer_load_dwordx4 v[56:59], v45, s[16:19], 0 offen offset:512 sc1
    buffer_load_dwordx4 v[60:63], v45, s[16:19], 0 offen offset:768 sc1
    s_waitcnt vmcnt(0)
    v_max3_u32 v40, v48, v52, v56
    v_max_u32 v40, v40, v60
    v_cmp_eq_u32 vcc, -1, v40
    s_nop 0
    s_cbranch_vccnz L_seg1g
    v_mfma_f32_16x16x32_bf16 v[64:67], v[48:51], a[128:131], 0
    v_mfma_f32_16x16x32_bf16 v[80:83], v[48:51], a[132:135], 0
    v_mfma_f32_16x16x32_bf16 v[68:71], v[48:51], a[136:139], 0
    v_mfma_f32_16x16x32_bf16 v[84:87], v[48:51], a[140:143], 0
    v_mfma_f32_16x16x32_bf16 v[72:75], v[48:51], a[144:147], 0
    v_mfma_f32_16x16x32_bf16 v[88:91], v[48:51], a[148:151], 0
    v_mfma_f32_16x16x32_bf16 v[76:79], v[48:51], a[152:155], 0
    v_mfma_f32_16x16x32_bf16 v[92:95], v[48:51], a[156:159], 0
    v_mfma_f32_16x16x32_bf16 v[64:67], v[52:55], a[160:163], v[64:67]
    v_mfma_f32_16x16x32_bf16 v[80:83], v[52:55], a[164:167], v[80:83]
    v_mfma_f32_16x16x32_bf16 v[68:71], v[52:55], a[168:171], v[68:71]
    v_mfma_f32_16x16x32_bf16 v[84:87], v[52:55], a[172:175], v[84:87]
    v_mfma_f32_16x16x32_bf16 v[72:75], v[52:55], a[176:179], v[72:75]
    v_mfma_f32_16x16x32_bf16 v[88:91], v[52:55], a[180:183], v[88:91]
    v_mfma_f32_16x16x32_bf16 v[76:79], v[52:55], a[184:187], v[76:79]
    v_mfma_f32_16x16x32_bf16 v[92:95], v[52:55], a[188:191], v[92:95]
    v_mfma_f32_16x16x32_bf16 v[64:67], v[56:59], a[192:195], v[64:67]
    v_mfma_f32_16x16x32_bf16 v[80:83], v[56:59], a[196:199], v[80:83]
    v_mfma_f32_16x16x32_bf16 v[68:71], v[56:59], a[200:203], v[68:71]
    v_mfma_f32_16x16x32_bf16 v[84:87], v[56:59], a[204:207], v[84:87]
    v_mfma_f32_16x16x32_bf16 v[72:75], v[56:59], a[208:211], v[72:75]
    v_mfma_f32_16x16x32_bf16 v[88:91], v[56:59], a[212:215], v[88:91]
    s_waitcnt vmcnt(0)
    s_cmp_ge_u32 s3, 0xff
    s_cbranch_scc1 L_noq
    buffer_load_dwordx4 v[16:19], v13, s[16:19], s65 offen offset:0 sc1
    buffer_load_dwordx4 v[20:23], v13, s[16:19], s65 offen offset:64 sc1
    buffer_load_dwordx4 v[24:27], v13, s[16:19], s65 offen offset:128 sc1
    buffer_load_dwordx4 v[28:31], v13, s[16:19], s65 offen offset:192 sc1
L_noq:
    s_cmp_eq_u32 s26, 0
    s_cbranch_scc1 L_nopf
    s_cmp_eq_u32 s37, 0
    s_cbranch_scc1 L_pf0
    s_add_u32 s67, s40, 16384
    buffer_load_dwordx4 v[16:19], v36, s[92:95], s67 offen offset:0 sc1
    buffer_load_dwordx4 v[24:27], v36, s[92:95], s67 offen offset:256 sc1
    s_add_u32 s67, s67, 8192
    buffer_load_dwordx4 v[20:23], v36, s[92:95], s67 offen offset:0 sc1
    buffer_load_dwordx4 v[28:31], v36, s[92:95], s67 offen offset:256 sc1
L_pf0:
    s_add_u32 s67, s40, 0
    buffer_load_dwordx4 v[96:99], v36, s[92:95], s67 offen offset:0 sc1
    buffer_load_dwordx4 v[124:127], v36, s[92:95], s67 offen offset:256 sc1
    s_add_u32 s67, s67, 8192
    buffer_load_dwordx4 v[100:103], v36, s[92:95], s67 offen offset:0 sc1
    buffer_load_dwordx4 v[128:131], v36, s[92:95], s67 offen offset:256 sc1
L_nopf:
    v_mfma_f32_16x16x32_bf16 v[76:79], v[56:59], a[216:219], v[76:79]
    v_mfma_f32_16x16x32_bf16 v[92:95], v[56:59], a[220:223], v[92:95]
    v_mfma_f32_16x16x32_bf16 v[64:67], v[60:63], a[224:227], v[64:67]
    v_mfma_f32_16x16x32_bf16 v[80:83], v[60:63], a[228:231], v[80:83]
    v_mfma_f32_16x16x32_bf16 v[68:71], v[60:63], a[232:235], v[68:71]
    v_mfma_f32_16x16x32_bf16 v[84:87], v[60:63], a[236:239], v[84:87]
    v_mfma_f32_16x16x32_bf16 v[72:75], v[60:63], a[240:243], v[72:75]
    v_mfma_f32_16x16x32_bf16 v[88:91], v[60:63], a[244:247], v[88:91]
    v_mfma_f32_16x16x32_bf16 v[76:79], v[60:63], a[248:251], v[76:79]
    v_mfma_f32_16x16x32_bf16 v[92:95], v[60:63], a[252:255], v[92:95]
    s_nop 2
    v_add_f32 v104, v64, v69
    v_add_f32 v108, v80, v85
    s_nop 1
    v_add_f32 v105, v74, v79
    v_add_f32 v109, v90, v95
    v_add_f32 v104, v104, v105
    v_add_f32 v108, v108, v109
    v_cmp_u_f32 vcc, v104, v108
    s_nop 0
    s_cbranch_vccnz L_seg1f
    s_mov_b64 exec, s[58:59]
    v_cvt_pk_bf16_f32 v105, v104, v108
    buffer_store_dword v105, v3, s[92:95], s38 offen sc1
    s_mov_b64 exec, -1
    s_setpc_b64 s[74:75]
L_seg2:
    s_sub_u32 s66, s66, 1
    s_cbranch_scc1 L_end
    s_cmp_eq_u32 s37, 1
    s_cbranch_scc1 L_g2a
L_g2b:
    s_add_u32 s67, s40, 0
    buffer_load_dwordx4 v[96:99], v36, s[92:95], s67 offen offset:0 sc1
    buffer_load_dwordx4 v[124:127], v36, s[92:95], s67 offen offset:256 sc1
    s_add_u32 s67, s67, 8192
    buffer_load_dwordx4 v[100:103], v36, s[92:95], s67 offen offset:0 sc1
    buffer_load_dwordx4 v[128:131], v36, s[92:95], s67 offen offset:256 sc1
    s_waitcnt vmcnt(0)
    v_max3_u32 v40, v96, v100, v124
    v_max_u32 v40, v40, v128
    v_cmp_eq_u32 vcc, -1, v40
    s_nop 0
    s_cbranch_vccnz L_seg2
L_seg2s:
    v_mfma_f32_16x16x32_bf16 v[80:83], v[132:135], v[96:99], 0
    v_mfma_f32_16x16x32_bf16 v[84:87], v[132:135], v[124:127], 0
    v_mfma_f32_16x16x32_bf16 v[80:83], v[132:135], v[100:103], v[80:83]
    v_mfma_f32_16x16x32_bf16 v[84:87], v[132:135], v[128:131], v[84:87]
    s_nop 7
    v_mov_b32_dpp v80, v84 quad_perm:[0,1,2,3] row_mask:0xc bank_mask:0xf
    v_mov_b32_dpp v81, v85 quad_perm:[0,1,2,3] row_mask:0xc bank_mask:0xf
    v_mov_b32_dpp v82, v86 quad_perm:[0,1,2,3] row_mask:0xc bank_mask:0xf
    v_mov_b32_dpp v83, v87 quad_perm:[0,1,2,3] row_mask:0xc bank_mask:0xf
    v_pk_add_f32 v[40:41], v[80:81], v[82:83]
    v_cvt_pk_bf16_f32 v84, v80, v81
    v_cvt_pk_bf16_f32 v85, v82, v83
    v_cmp_u_f32 vcc, v40, v41
    v_and_b32 v81, s39, v84
    v_lshlrev_b32 v80, 16, v84
    v_and_b32 v83, s39, v85
    v_lshlrev_b32 v82, 16, v85
    s_nop 0
    s_cbranch_vccnz L_seg2
    s_cmp_eq_u32 s37, 1
    s_cbranch_scc1 L_g2c
L_g2d:
    v_pk_add_f32 v[80:81], v[80:81], v[112:113]
    v_pk_add_f32 v[82:83], v[82:83], v[114:115]
    v_cvt_pk_bf16_f32 v84, v80, v81
    v_cvt_pk_bf16_f32 v85, v82, v83
    ds_write_b64 v37, v[84:85] offset:0
    v_and_b32 v113, s39, v84
    v_lshlrev_b32 v112, 16, v84
    v_and_b32 v115, s39, v85
    v_lshlrev_b32 v114, 16, v85
    v_add_f32 v40, v112, v113
    v_mul_f32 v41, v112, v112
    v_add_f32 v42, v114, v115
    v_fmac_f32 v41, v113, v113
    v_add_f32 v40, v40, v42
    v_fmac_f32 v41, v114, v114
    v_fmac_f32 v41, v115, v115
    v_add_f32_dpp v40, v40, v40 quad_perm:[1,0,3,2] row_mask:0xf bank_mask:0xf
    s_nop 0
    v_add_f32_dpp v41, v41, v41 quad_perm:[1,0,3,2] row_mask:0xf bank_mask:0xf
    v_add_f32_dpp v40, v40, v40 quad_perm:[2,3,0,1] row_mask:0xf bank_mask:0xf
    s_nop 0
    v_add_f32_dpp v41, v41, v41 quad_perm:[2,3,0,1] row_mask:0xf bank_mask:0xf
    ds_write_b64 v9, v[40:41] offset:0
    s_waitcnt lgkmcnt(0)
    s_barrier
    ds_read_b128 v[48:51], v2 offset:4352
    ds_read_b128 v[16:19], v34
    ds_read_b128 v[52:55], v2 offset:4608
    ds_read_b128 v[56:59], v2 offset:4864
    ds_read_b128 v[60:63], v2 offset:5120
    s_waitcnt lgkmcnt(4)
    v_mfma_f32_16x16x32_bf16 v[64:67], v[48:51], v[136:139], 0
    s_waitcnt lgkmcnt(3)
    v_mfma_f32_16x16x32_bf16 v[68:71], v[48:51], v[140:143], 0
    v_pk_add_f32 v[16:17], v[16:17], v[18:19]
    s_nop 1
    v_add_f32_dpp v16, v16, v16 row_ror:1 row_mask:0xf bank_mask:0xf
    v_mfma_f32_16x16x32_bf16 v[72:75], v[48:51], v[144:147], 0
    v_add_f32_dpp v17, v17, v17 row_ror:1 row_mask:0xf bank_mask:0xf
    v_add_f32_dpp v16, v16, v16 row_ror:2 row_mask:0xf bank_mask:0xf
    v_mfma_f32_16x16x32_bf16 v[76:79], v[48:51], v[148:151], 0
    v_add_f32_dpp v17, v17, v17 row_ror:2 row_mask:0xf bank_mask:0xf
    v_add_f32_dpp v16, v16, v16 row_ror:4 row_mask:0xf bank_mask:0xf
    s_waitcnt lgkmcnt(2)
    v_mfma_f32_16x16x32_bf16 v[64:67], v[52:55], v[152:155], v[64:67]
    v_add_f32_dpp v17, v17, v17 row_ror:4 row_mask:0xf bank_mask:0xf
    v_add_f32_dpp v16, v16, v16 row_ror:8 row_mask:0xf bank_mask:0xf
    v_mfma_f32_16x16x32_bf16 v[68:71], v[52:55], v[156:159], v[68:71]
    v_add_f32_dpp v17, v17, v17 row_ror:8 row_mask:0xf bank_mask:0xf
    v_mul_f32 v16, 0x3b000000, v16
    v_mfma_f32_16x16x32_bf16 v[72:75], v[52:55], v[160:163], v[72:75]
    v_mul_f32 v17, 0x3b000000, v17
    v_fma_f32 v17, -v16, v16, v17
    v_mfma_f32_16x16x32_bf16 v[76:79], v[52:55], v[164:167], v[76:79]
    v_cvt_pk_bf16_f32 v16, v16, v16
    v_max_f32 v17, 0, v17
    s_waitcnt lgkmcnt(1)
    v_mfma_f32_16x16x32_bf16 v[64:67], v[56:59], v[168:171], v[64:67]
    v_and_b32 v16, s39, v16
    v_cvt_pk_bf16_f32 v17, v17, v17
    v_mfma_f32_16x16x32_bf16 v[68:71], v[56:59], v[172:175], v[68:71]
    v_and_b32 v17, s39, v17
    v_add_f32 v17, 0x3727c5ac, v17
    v_mfma_f32_16x16x32_bf16 v[72:75], v[56:59], v[176:179], v[72:75]
    v_cvt_pk_bf16_f32 v17, v17, v17
    v_and_b32 v17, s39, v17
    v_mfma_f32_16x16x32_bf16 v[76:79], v[56:59], v[180:183], v[76:79]
    v_sqrt_f32 v17, v17
    s_nop 0
    v_cvt_pk_bf16_f32 v17, v17, v17
    s_waitcnt lgkmcnt(0)
    v_mfma_f32_16x16x32_bf16 v[64:67], v[60:63], v[184:187], v[64:67]
    v_and_b32 v17, s39, v17
    v_rcp_f32 v17, v17
    v_mfma_f32_16x16x32_bf16 v[68:71], v[60:63], v[188:191], v[68:71]
    v_mfma_f32_16x16x32_bf16 v[72:75], v[60:63], v[192:195], v[72:75]
    v_mfma_f32_16x16x32_bf16 v[76:79], v[60:63], v[196:199], v[76:79]
    s_nop 5
    v_add_f32 v104, v64, v69
    s_nop 0
    v_add_f32 v105, v74, v79
    v_add_f32 v104, v104, v105
    v_fma_f32 v104, -v16, v122, v104
    v_mul_f32 v104, v104, v17
    v_cvt_pk_bf16_f32 v104, v104, v104
    v_and_b32 v104, s39, v104
    v_mul_f32 v105, 0xbfb8aa3b, v104
    v_exp_f32 v105, v105
    s_nop 0
    v_add_f32 v105, 1.0, v105
    v_rcp_f32 v105, v105
    s_nop 0
    v_mul_f32 v104, v104, v105
    s_nop 1
    v_mov_b32_dpp v105, v104 quad_perm:[1,0,3,2] row_mask:0xf bank_mask:0xf
    v_cvt_pk_bf16_f32 v104, v104, v105
    s_mov_b64 exec, s[46:47]
    s_cmp_eq_u32 s4, 0
    s_cbranch_scc1 Lg_41
    buffer_store_dword v104, v8, s[16:19], s41 offen
Lb_42:
    s_mov_b64 exec, -1
    s_waitcnt vmcnt(0)
Lh_43:
    s_sub_u32 s66, s66, 1
    s_cbranch_scc1 L_end
    buffer_load_dwordx4 v[48:51], v10, s[16:19], s41 offen sc1
    buffer_load_dwordx4 v[52:55], v10, s[16:19], s41 offen offset:192 sc1
    s_waitcnt vmcnt(0)
    v_max3_u32 v40, v48, v49, v50
    v_max3_u32 v41, v51, v52, v53
    v_max3_u32 v40, v40, v54, v55
    v_max_u32 v40, v40, v41
    v_cmp_eq_u32 vcc, -1, v40
    s_nop 0
    s_cbranch_vccnz Lh_43
    v_mfma_f32_16x16x32_bf16 v[64:67], v[48:51], v[200:203], 0
    v_mfma_f32_16x16x32_bf16 v[80:83], v[48:51], v[204:207], 0
    v_mfma_f32_16x16x32_bf16 v[68:71], v[48:51], v[208:211], 0
    v_mfma_f32_16x16x32_bf16 v[84:87], v[48:51], v[212:215], 0
    v_mfma_f32_16x16x32_bf16 v[72:75], v[48:51], v[216:219], 0
    v_mfma_f32_16x16x32_bf16 v[88:91], v[48:51], v[220:223], 0
    v_mfma_f32_16x16x32_bf16 v[76:79], v[48:51], v[224:227], 0
    v_mfma_f32_16x16x32_bf16 v[92:95], v[48:51], v[228:231], 0
    v_mfma_f32_16x16x32_bf16 v[68:71], v[52:55], v[232:235], v[68:71]
    v_mfma_f32_16x16x32_bf16 v[84:87], v[52:55], v[236:239], v[84:87]
    v_mfma_f32_16x16x32_bf16 v[72:75], v[52:55], v[240:243], v[72:75]
    v_mfma_f32_16x16x32_bf16 v[88:91], v[52:55], v[244:247], v[88:91]
    v_mfma_f32_16x16x32_bf16 v[76:79], v[52:55], v[248:251], v[76:79]
    v_mfma_f32_16x16x32_bf16 v[92:95], v[52:55], v[252:255], v[92:95]
    s_waitcnt vmcnt(0)
    s_nop 1
    v_add_f32 v104, v64, v69
    v_add_f32 v108, v80, v85
    s_nop 1
    v_add_f32 v105, v74, v79
    v_add_f32 v109, v90, v95
    v_add_f32 v104, v104, v105
    v_add_f32 v108, v108, v109
    s_add_u32 s40, s40, 180224
    s_mov_b64 exec, s[44:45]
    v_cvt_pk_bf16_f32 v105, v104, v108
    buffer_store_dword v105, v3, s[92:95], s40 offen sc1
    s_mov_b64 exec, -1
    s_setpc_b64 s[74:75]
L_seg3:
    s_sub_u32 s66, s66, 1
    s_cbranch_scc1 L_end
    s_cmp_eq_u32 s37, 1
    s_cbranch_scc1 L_g3a
L_g3b:
    s_add_u32 s67, s40, 0
    buffer_load_dwordx4 v[96:99], v36, s[92:95], s67 offen offset:0 sc1
    buffer_load_dwordx4 v[124:127], v36, s[92:95], s67 offen offset:256 sc1
    s_add_u32 s67, s67, 8192
    buffer_load_dwordx4 v[100:103], v36, s[92:95], s67 offen offset:0 sc1
    buffer_load_dwordx4 v[128:131], v36, s[92:95], s67 offen offset:256 sc1
    s_waitcnt vmcnt(0)
    v_max3_u32 v40, v96, v100, v124
    v_max_u32 v40, v40, v128
    v_cmp_eq_u32 vcc, -1, v40
    s_nop 0
    s_cbranch_vccnz L_seg3
L_seg3s:
    v_mfma_f32_16x16x32_bf16 v[80:83], v[132:135], v[96:99], 0
    v_mfma_f32_16x16x32_bf16 v[84:87], v[132:135], v[124:127], 0
    v_mfma_f32_16x16x32_bf16 v[80:83], v[132:135], v[100:103], v[80:83]
    v_mfma_f32_16x16x32_bf16 v[84:87], v[132:135], v[128:131], v[84:87]
    s_nop 7
    v_mov_b32_dpp v80, v84 quad_perm:[0,1,2,3] row_mask:0xc bank_mask:0xf
    v_mov_b32_dpp v81, v85 quad_perm:[0,1,2,3] row_mask:0xc bank_mask:0xf
    v_mov_b32_dpp v82, v86 quad_perm:[0,1,2,3] row_mask:0xc bank_mask:0xf
    v_mov_b32_dpp v83, v87 quad_perm:[0,1,2,3] row_mask:0xc bank_mask:0xf
    v_pk_add_f32 v[40:41], v[80:81], v[82:83]
    v_cvt_pk_bf16_f32 v84, v80, v81
    v_cvt_pk_bf16_f32 v85, v82, v83
    v_cmp_u_f32 vcc, v40, v41
    v_and_b32 v81, s39, v84
    v_lshlrev_b32 v80, 16, v84
    v_and_b32 v83, s39, v85
    v_lshlrev_b32 v82, 16, v85
    s_nop 0
    s_cbranch_vccnz L_seg3
    s_cmp_eq_u32 s37, 1
    s_cbranch_scc1 L_g3c
L_g3d:
    v_pk_add_f32 v[80:81], v[80:81], v[112:113]
    v_pk_add_f32 v[82:83], v[82:83], v[114:115]
    v_cvt_pk_bf16_f32 v84, v80, v81
    v_cvt_pk_bf16_f32 v85, v82, v83
    s_mov_b64 exec, s[50:51]
    s_cbranch_execz Lo_44
    buffer_store_dwordx2 v[84:85], v38, s[96:99], 0 offen
Lo_44:
    s_mov_b64 exec, -1
    ds_write_b64 v37, v[84:85] offset:0
    v_and_b32 v113, s39, v84
    v_lshlrev_b32 v112, 16, v84
    v_and_b32 v115, s39, v85
    v_lshlrev_b32 v114, 16, v85
    v_add_f32 v40, v112, v113
    v_mul_f32 v41, v112, v112
    v_add_f32 v42, v114, v115
    v_fmac_f32 v41, v113, v113
    v_add_f32 v40, v40, v42
    v_fmac_f32 v41, v114, v114
    v_fmac_f32 v41, v115, v115
    v_add_f32_dpp v40, v40, v40 quad_perm:[1,0,3,2] row_mask:0xf bank_mask:0xf
    s_nop 0
    v_add_f32_dpp v41, v41, v41 quad_perm:[1,0,3,2] row_mask:0xf bank_mask:0xf
    v_add_f32_dpp v40, v40, v40 quad_perm:[2,3,0,1] row_mask:0xf bank_mask:0xf
    s_nop 0
    v_add_f32_dpp v41, v41, v41 quad_perm:[2,3,0,1] row_mask:0xf bank_mask:0xf
    ds_write_b64 v9, v[40:41] offset:0
    v_add_u32 v42, 145216, v38
    ds_write_b64 v42, v[84:85]
    s_cmp_eq_u32 s48, 0
    s_cbranch_scc1 Lr_45
    s_waitcnt lgkmcnt(0)
    s_barrier
    ds_read_b128 v[48:51], v2 offset:4352
    ds_read_b128 v[16:19], v34
    ds_read_b128 v[52:55], v2 offset:4608
    ds_read_b128 v[56:59], v2 offset:4864
    ds_read_b128 v[60:63], v2 offset:5120
    s_waitcnt lgkmcnt(4)
    v_mfma_f32_16x16x32_bf16 v[64:67], v[48:51], a[0:3], 0
    v_mfma_f32_16x16x32_bf16 v[80:83], v[48:51], a[4:7], 0
    s_cmp_eq_u32 s26, 0
    s_cbranch_scc1 L_nopf3
    s_add_u32 s67, s38, 0
    buffer_load_dwordx4 v[96:99], v36, s[92:95], s67 offen offset:0 sc1
    buffer_load_dwordx4 v[124:127], v36, s[92:95], s67 offen offset:256 sc1
    s_add_u32 s67, s67, 8192
    buffer_load_dwordx4 v[100:103], v36, s[92:95], s67 offen offset:0 sc1
    buffer_load_dwordx4 v[128:131], v36, s[92:95], s67 offen offset:256 sc1
L_nopf3:
    s_waitcnt lgkmcnt(3)
    v_mfma_f32_16x16x32_bf16 v[68:71], v[48:51], a[8:11], 0
    v_pk_add_f32 v[16:17], v[16:17], v[18:19]
    v_mfma_f32_16x16x32_bf16 v[84:87], v[48:51], a[12:15], 0
    s_nop 0
    v_add_f32_dpp v16, v16, v16 row_ror:1 row_mask:0xf bank_mask:0xf
    v_mfma_f32_16x16x32_bf16 v[72:75], v[48:51], a[16:19], 0
    v_add_f32_dpp v17, v17, v17 row_ror:1 row_mask:0xf bank_mask:0xf
    v_mfma_f32_16x16x32_bf16 v[88:91], v[48:51], a[20:23], 0
    v_add_f32_dpp v16, v16, v16 row_ror:2 row_mask:0xf bank_mask:0xf
    v_mfma_f32_16x16x32_bf16 v[76:79], v[48:51], a[24:27], 0
    v_add_f32_dpp v17, v17, v17 row_ror:2 row_mask:0xf bank_mask:0xf
    v_mfma_f32_16x16x32_bf16 v[92:95], v[48:51], a[28:31], 0
    v_add_f32_dpp v16, v16, v16 row_ror:4 row_mask:0xf bank_mask:0xf
    s_waitcnt lgkmcnt(2)
    v_mfma_f32_16x16x32_bf16 v[64:67], v[52:55], a[32:35], v[64:67]
    v_add_f32_dpp v17, v17, v17 row_ror:4 row_mask:0xf bank_mask:0xf
    v_mfma_f32_16x16x32_bf16 v[80:83], v[52:55], a[36:39], v[80:83]
    v_add_f32_dpp v16, v16, v16 row_ror:8 row_mask:0xf bank_mask:0xf
    v_mfma_f32_16x16x32_bf16 v[68:71], v[52:55], a[40:43], v[68:71]
    v_add_f32_dpp v17, v17, v17 row_ror:8 row_mask:0xf bank_mask:0xf
    v_mfma_f32_16x16x32_bf16 v[84:87], v[52:55], a[44:47], v[84:87]
    v_mul_f32 v16, 0x3b000000, v16
    v_mfma_f32_16x16x32_bf16 v[72:75], v[52:55], a[48:51], v[72:75]
    v_mul_f32 v17, 0x3b000000, v17
    v_mfma_f32_16x16x32_bf16 v[88:91], v[52:55], a[52:55], v[88:91]
    v_fma_f32 v17, -v16, v16, v17
    v_mfma_f32_16x16x32_bf16 v[76:79], v[52:55], a[56:59], v[76:79]
    v_cvt_pk_bf16_f32 v16, v16, v16
    v_mfma_f32_16x16x32_bf16 v[92:95], v[52:55], a[60:63], v[92:95]
    v_max_f32 v17, 0, v17
    s_waitcnt lgkmcnt(1)
    v_mfma_f32_16x16x32_bf16 v[64:67], v[56:59], a[64:67], v[64:67]
    v_and_b32 v16, s39, v16
    v_mfma_f32_16x16x32_bf16 v[80:83], v[56:59], a[68:71], v[80:83]
    v_cvt_pk_bf16_f32 v17, v17, v17
    v_mfma_f32_16x16x32_bf16 v[68:71], v[56:59], a[72:75], v[68:71]
    v_and_b32 v17, s39, v17
    v_mfma_f32_16x16x32_bf16 v[84:87], v[56:59], a[76:79], v[84:87]
    v_add_f32 v17, 0x3727c5ac, v17
    v_mfma_f32_16x16x32_bf16 v[72:75], v[56:59], a[80:83], v[72:75]
    v_cvt_pk_bf16_f32 v17, v17, v17
    v_mfma_f32_16x16x32_bf16 v[88:91], v[56:59], a[84:87], v[88:91]
    v_and_b32 v17, s39, v17
    v_mfma_f32_16x16x32_bf16 v[76:79], v[56:59], a[88:91], v[76:79]
    v_sqrt_f32 v17, v17
    v_mfma_f32_16x16x32_bf16 v[92:95], v[56:59], a[92:95], v[92:95]
    v_cvt_pk_bf16_f32 v17, v17, v17
    s_waitcnt lgkmcnt(0)
    v_mfma_f32_16x16x32_bf16 v[64:67], v[60:63], a[96:99], v[64:67]
    v_and_b32 v17, s39, v17
    v_mfma_f32_16x16x32_bf16 v[80:83], v[60:63], a[100:103], v[80:83]
    v_rcp_f32 v17, v17
    v_mfma_f32_16x16x32_bf16 v[68:71], v[60:63], a[104:107], v[68:71]
    v_mfma_f32_16x16x32_bf16 v[84:87], v[60:63], a[108:111], v[84:87]
    v_mfma_f32_16x16x32_bf16 v[72:75], v[60:63], a[112:115], v[72:75]
    v_mfma_f32_16x16x32_bf16 v[88:91], v[60:63], a[116:119], v[88:91]
    v_mfma_f32_16x16x32_bf16 v[76:79], v[60:63], a[120:123], v[76:79]
    v_mfma_f32_16x16x32_bf16 v[92:95], v[60:63], a[124:127], v[92:95]
    s_nop 2
    v_add_f32 v104, v64, v69
    v_add_f32 v108, v80, v85
    s_nop 1
    v_add_f32 v105, v74, v79
    v_add_f32 v109, v90, v95
    v_add_f32 v104, v104, v105
    v_add_f32 v108, v108, v109
    v_fma_f32 v104, -v16, v120, v104
    v_fma_f32 v108, -v16, v121, v108
    v_mul_f32 v104, v104, v17
    v_mul_f32 v108, v108, v17
    s_nop 1
    v_mov_b32_dpp v40, v108 quad_perm:[1,0,3,2] row_mask:0xf bank_mask:0xf
    v_mov_b32_dpp v41, v104 quad_perm:[1,0,3,2] row_mask:0xf bank_mask:0xf
    v_cndmask_b32 v40, v40, v104, s[62:63]
    v_cndmask_b32 v41, v108, v41, s[62:63]
    v_cvt_pk_bf16_f32 v104, v40, v41
    s_mov_b64 exec, s[48:49]
    s_cmp_eq_u32 s4, 0
    s_cbranch_scc1 Lg_46
    buffer_store_dword v104, v4, s[16:19], s54 offen
Lb_47:
    s_mov_b64 exec, -1
Lr_45:
    s_setpc_b64 s[74:75]
L_g2a:
    s_add_u32 s67, s40, 16384
    buffer_load_dwordx4 v[16:19], v36, s[92:95], s67 offen offset:0 sc1
    buffer_load_dwordx4 v[24:27], v36, s[92:95], s67 offen offset:256 sc1
    s_add_u32 s67, s67, 8192
    buffer_load_dwordx4 v[20:23], v36, s[92:95], s67 offen offset:0 sc1
    buffer_load_dwordx4 v[28:31], v36, s[92:95], s67 offen offset:256 sc1
    s_branch L_g2b
L_g2c:
    v_mfma_f32_16x16x32_bf16 v[88:91], v[132:135], v[16:19], 0
    v_mfma_f32_16x16x32_bf16 v[92:95], v[132:135], v[24:27], 0
    v_mfma_f32_16x16x32_bf16 v[88:91], v[132:135], v[20:23], v[88:91]
    v_mfma_f32_16x16x32_bf16 v[92:95], v[132:135], v[28:31], v[92:95]
    s_nop 7
    v_mov_b32_dpp v88, v92 quad_perm:[0,1,2,3] row_mask:0xc bank_mask:0xf
    v_mov_b32_dpp v89, v93 quad_perm:[0,1,2,3] row_mask:0xc bank_mask:0xf
    v_mov_b32_dpp v90, v94 quad_perm:[0,1,2,3] row_mask:0xc bank_mask:0xf
    v_mov_b32_dpp v91, v95 quad_perm:[0,1,2,3] row_mask:0xc bank_mask:0xf
    v_pk_add_f32 v[40:41], v[88:89], v[90:91]
    v_cvt_pk_bf16_f32 v92, v88, v89
    v_cvt_pk_bf16_f32 v93, v90, v91
    v_cmp_u_f32 vcc, v40, v41
    v_and_b32 v89, s39, v92
    v_lshlrev_b32 v88, 16, v92
    v_and_b32 v91, s39, v93
    v_lshlrev_b32 v90, 16, v93
    s_nop 0
    s_cbranch_vccnz L_seg2
    v_pk_add_f32 v[88:89], v[88:89], v[116:117]
    v_pk_add_f32 v[90:91], v[90:91], v[118:119]
    v_cvt_pk_bf16_f32 v92, v88, v89
    v_cvt_pk_bf16_f32 v93, v90, v91
    ds_write_b64 v37, v[92:93] offset:2176
    v_and_b32 v117, s39, v92
    v_lshlrev_b32 v116, 16, v92
    v_and_b32 v119, s39, v93
    v_lshlrev_b32 v118, 16, v93
    v_add_f32 v40, v116, v117
    v_mul_f32 v41, v116, v116
    v_add_f32 v42, v118, v119
    v_fmac_f32 v41, v117, v117
    v_add_f32 v40, v40, v42
    v_fmac_f32 v41, v118, v118
    v_fmac_f32 v41, v119, v119
    v_add_f32_dpp v40, v40, v40 quad_perm:[1,0,3,2] row_mask:0xf bank_mask:0xf
    s_nop 0
    v_add_f32_dpp v41, v41, v41 quad_perm:[1,0,3,2] row_mask:0xf bank_mask:0xf
    v_add_f32_dpp v40, v40, v40 quad_perm:[2,3,0,1] row_mask:0xf bank_mask:0xf
    s_nop 0
    v_add_f32_dpp v41, v41, v41 quad_perm:[2,3,0,1] row_mask:0xf bank_mask:0xf
    ds_write_b64 v9, v[40:41] offset:2176
    s_branch L_g2d
L_g3a:
    s_add_u32 s67, s40, 16384
    buffer_load_dwordx4 v[16:19], v36, s[92:95], s67 offen offset:0 sc1
    buffer_load_dwordx4 v[24:27], v36, s[92:95], s67 offen offset:256 sc1
    s_add_u32 s67, s67, 8192
    buffer_load_dwordx4 v[20:23], v36, s[92:95], s67 offen offset:0 sc1
    buffer_load_dwordx4 v[28:31], v36, s[92:95], s67 offen offset:256 sc1
    s_branch L_g3b
L_g3c:
    v_mfma_f32_16x16x32_bf16 v[88:91], v[132:135], v[16:19], 0
    v_mfma_f32_16x16x32_bf16 v[92:95], v[132:135], v[24:27], 0
    v_mfma_f32_16x16x32_bf16 v[88:91], v[132:135], v[20:23], v[88:91]
    v_mfma_f32_16x16x32_bf16 v[92:95], v[132:135], v[28:31], v[92:95]
    s_nop 7
    v_mov_b32_dpp v88, v92 quad_perm:[0,1,2,3] row_mask:0xc bank_mask:0xf
    v_mov_b32_dpp v89, v93 quad_perm:[0,1,2,3] row_mask:0xc bank_mask:0xf
    v_mov_b32_dpp v90, v94 quad_perm:[0,1,2,3] row_mask:0xc bank_mask:0xf
    v_mov_b32_dpp v91, v95 quad_perm:[0,1,2,3] row_mask:0xc bank_mask:0xf
    v_pk_add_f32 v[40:41], v[88:89], v[90:91]
    v_cvt_pk_bf16_f32 v92, v88, v89
    v_cvt_pk_bf16_f32 v93, v90, v91
    v_cmp_u_f32 vcc, v40, v41
    v_and_b32 v89, s39, v92
    v_lshlrev_b32 v88, 16, v92
    v_and_b32 v91, s39, v93
    v_lshlrev_b32 v90, 16, v93
    s_nop 0
    s_cbranch_vccnz L_seg3
    v_pk_add_f32 v[88:89], v[88:89], v[116:117]
    v_pk_add_f32 v[90:91], v[90:91], v[118:119]
    v_cvt_pk_bf16_f32 v92, v88, v89
    v_cvt_pk_bf16_f32 v93, v90, v91
    s_mov_b64 exec, s[52:53]
    s_cbranch_execz Lo_48
    buffer_store_dwordx2 v[92:93], v39, s[96:99], 0 offen
Lo_48:
    s_mov_b64 exec, -1
    ds_write_b64 v37, v[92:93] offset:2176
    v_and_b32 v117, s39, v92
    v_lshlrev_b32 v116, 16, v92
    v_and_b32 v119, s39, v93
    v_lshlrev_b32 v118, 16, v93
    v_add_f32 v40, v116, v117
    v_mul_f32 v41, v116, v116
    v_add_f32 v42, v118, v119
    v_fmac_f32 v41, v117, v117
    v_add_f32 v40, v40, v42
    v_fmac_f32 v41, v118, v118
    v_fmac_f32 v41, v119, v119
    v_add_f32_dpp v40, v40, v40 quad_perm:[1,0,3,2] row_mask:0xf bank_mask:0xf
    s_nop 0
    v_add_f32_dpp v41, v41, v41 quad_perm:[1,0,3,2] row_mask:0xf bank_mask:0xf
    v_add_f32_dpp v40, v40, v40 quad_perm:[2,3,0,1] row_mask:0xf bank_mask:0xf
    s_nop 0
    v_add_f32_dpp v41, v41, v41 quad_perm:[2,3,0,1] row_mask:0xf bank_mask:0xf
    ds_write_b64 v9, v[40:41] offset:2176
    v_add_u32 v42, 145216, v39
    ds_write_b64 v42, v[92:93]
    s_branch L_g3d
L_dc2:
    s_sub_u32 s66, s66, 1
    s_cbranch_scc1 L_end
    s_add_u32 s67, s64, 16384
    buffer_load_dwordx2 v[56:57], v12, s[16:19], s64 offen sc1
    buffer_load_dwordx2 v[58:59], v12, s[16:19], s64 offen offset:512 sc1
    buffer_load_dwordx4 v[48:51], v11, s[16:19], s64 offen sc1
    buffer_load_dwordx4 v[52:55], v11, s[16:19], s67 offen sc1
    s_add_u32 s67, s72, 16384
    buffer_load_dwordx2 v[72:73], v12, s[16:19], s72 offen sc1
    buffer_load_dwordx2 v[74:75], v12, s[16:19], s72 offen offset:512 sc1
    buffer_load_dwordx4 v[64:67], v11, s[16:19], s72 offen sc1
    buffer_load_dwordx4 v[68:71], v11, s[16:19], s67 offen sc1
    s_waitcnt vmcnt(0)
    v_max3_u32 v40, v56, v58, v48
    v_max3_u32 v42, v50, v52, v54
    v_max3_u32 v41, v72, v74, v64
    v_max3_u32 v43, v66, v68, v70
    v_max3_u32 v40, v40, v41, v43
    v_max_u32 v40, v40, v42
    v_cmp_eq_u32 vcc, -1, v40
    s_nop 0
    s_cbranch_vccnz L_dc2
    v_max_f32 v60, v56, v58
    v_max_f32 v76, v72, v74
    s_nop 0
    v_max_f32_dpp v60, v60, v60 row_ror:4 row_mask:0xf bank_mask:0xf
    v_max_f32_dpp v76, v76, v76 row_ror:4 row_mask:0xf bank_mask:0xf
    s_nop 0
    v_max_f32_dpp v60, v60, v60 row_ror:8 row_mask:0xf bank_mask:0xf
    v_max_f32_dpp v76, v76, v76 row_ror:8 row_mask:0xf bank_mask:0xf
    v_mov_b32 v61, v60
    v_mov_b32 v77, v76
    s_nop 0
    v_permlane16_swap_b32 v60, v61
    v_permlane16_swap_b32 v76, v77
    v_max_f32 v60, v60, v61
    v_max_f32 v76, v76, v77
    v_mov_b32 v61, v60
    v_mov_b32 v77, v76
    s_nop 0
    v_permlane32_swap_b32 v60, v61
    v_permlane32_swap_b32 v76, v77
    v_max_f32 v60, v60, v61
    v_max_f32 v76, v76, v77
    v_sub_f32 v56, v56, v60
    v_sub_f32 v72, v72, v76
    v_sub_f32 v58, v58, v60
    v_sub_f32 v74, v74, v76
    v_cvt_i32_f32 v56, v56
    v_cvt_i32_f32 v72, v72
    v_cvt_i32_f32 v58, v58
    v_cvt_i32_f32 v74, v74
    v_ldexp_f32 v56, 1.0, v56
    v_ldexp_f32 v72, 1.0, v72
    v_ldexp_f32 v58, 1.0, v58
    v_ldexp_f32 v74, 1.0, v74
    v_lshrrev_b32 v62, 16, v56
    v_lshrrev_b32 v78, 16, v72
    v_lshrrev_b32 v63, 16, v58
    v_lshrrev_b32 v79, 16, v74
    v_mul_f32 v57, v57, v56
    v_mul_f32 v73, v73, v72
    v_and_b32 v56, s39, v56
    v_and_b32 v72, s39, v72
    v_fmac_f32 v57, v59, v58
    v_fmac_f32 v73, v75, v74
    v_and_b32 v58, s39, v58
    v_and_b32 v74, s39, v74
    v_dot2_f32_bf16 v80, v62, v48, 0
    v_dot2_f32_bf16 v88, v78, v64, 0
    v_dot2_f32_bf16 v81, v56, v48, 0
    v_dot2_f32_bf16 v89, v72, v64, 0
    v_add_f32_dpp v57, v57, v57 row_ror:1 row_mask:0xf bank_mask:0xf
    v_add_f32_dpp v73, v73, v73 row_ror:1 row_mask:0xf bank_mask:0xf
    v_dot2_f32_bf16 v82, v62, v49, 0
    v_dot2_f32_bf16 v90, v78, v65, 0
    v_dot2_f32_bf16 v83, v56, v49, 0
    v_dot2_f32_bf16 v91, v72, v65, 0
    v_add_f32_dpp v57, v57, v57 row_ror:2 row_mask:0xf bank_mask:0xf
    v_add_f32_dpp v73, v73, v73 row_ror:2 row_mask:0xf bank_mask:0xf
    v_dot2_f32_bf16 v84, v62, v50, 0
    v_dot2_f32_bf16 v92, v78, v66, 0
    v_dot2_f32_bf16 v85, v56, v50, 0
    v_dot2_f32_bf16 v93, v72, v66, 0
    v_add_f32_dpp v57, v57, v57 row_ror:4 row_mask:0xf bank_mask:0xf
    v_add_f32_dpp v73, v73, v73 row_ror:4 row_mask:0xf bank_mask:0xf
    v_dot2_f32_bf16 v86, v62, v51, 0
    v_dot2_f32_bf16 v94, v78, v67, 0
    v_dot2_f32_bf16 v87, v56, v51, 0
    v_dot2_f32_bf16 v95, v72, v67, 0
    v_add_f32_dpp v57, v57, v57 row_ror:8 row_mask:0xf bank_mask:0xf
    v_add_f32_dpp v73, v73, v73 row_ror:8 row_mask:0xf bank_mask:0xf
    v_dot2_f32_bf16 v80, v63, v52, v80
    v_dot2_f32_bf16 v88, v79, v68, v88
    v_dot2_f32_bf16 v81, v58, v52, v81
    v_dot2_f32_bf16 v89, v74, v68, v89
    v_mov_b32 v61, v57
    v_mov_b32 v77, v73
    v_dot2_f32_bf16 v82, v63, v53, v82
    v_dot2_f32_bf16 v90, v79, v69, v90
    v_dot2_f32_bf16 v83, v58, v53, v83
    v_dot2_f32_bf16 v91, v74, v69, v91
    v_permlane16_swap_b32 v57, v61
    v_permlane16_swap_b32 v73, v77
    v_dot2_f32_bf16 v84, v63, v54, v84
    v_dot2_f32_bf16 v92, v79, v70, v92
    v_dot2_f32_bf16 v85, v58, v54, v85
    v_dot2_f32_bf16 v93, v74, v70, v93
    v_add_f32 v57, v57, v61
    v_add_f32 v73, v73, v77
    v_dot2_f32_bf16 v86, v63, v55, v86
    v_dot2_f32_bf16 v94, v79, v71, v94
    v_dot2_f32_bf16 v87, v58, v55, v87
    v_dot2_f32_bf16 v95, v74, v71, v95
    v_mov_b32 v61, v57
    v_mov_b32 v77, v73
    v_permlane16_swap_b32 v80, v82
    v_permlane16_swap_b32 v88, v90
    v_permlane16_swap_b32 v81, v83
    v_permlane16_swap_b32 v89, v91
    v_permlane32_swap_b32 v57, v61
    v_permlane32_swap_b32 v73, v77
    v_permlane16_swap_b32 v84, v86
    v_permlane16_swap_b32 v92, v94
    v_permlane16_swap_b32 v85, v87
    v_permlane16_swap_b32 v93, v95
    v_add_f32 v57, v57, v61
    v_add_f32 v73, v73, v77
    v_pk_add_f32 v[80:81], v[80:81], v[82:83]
    v_pk_add_f32 v[88:89], v[88:89], v[90:91]
    v_pk_add_f32 v[84:85], v[84:85], v[86:87]
    v_pk_add_f32 v[92:93], v[92:93], v[94:95]
    v_rcp_f32 v57, v57
    v_rcp_f32 v73, v73
    v_permlane32_swap_b32 v80, v84
    v_permlane32_swap_b32 v88, v92
    v_permlane32_swap_b32 v81, v85
    v_permlane32_swap_b32 v89, v93
    v_pk_add_f32 v[80:81], v[80:81], v[84:85]
    v_pk_add_f32 v[88:89], v[88:89], v[92:93]
    s_nop 0
    v_add_f32_dpp v80, v80, v80 row_ror:4 row_mask:0xf bank_mask:0xf
    v_add_f32_dpp v88, v88, v88 row_ror:4 row_mask:0xf bank_mask:0xf
    v_add_f32_dpp v81, v81, v81 row_ror:4 row_mask:0xf bank_mask:0xf
    v_add_f32_dpp v89, v89, v89 row_ror:4 row_mask:0xf bank_mask:0xf
    v_add_f32_dpp v80, v80, v80 row_ror:8 row_mask:0xf bank_mask:0xf
    v_add_f32_dpp v88, v88, v88 row_ror:8 row_mask:0xf bank_mask:0xf
    v_add_f32_dpp v81, v81, v81 row_ror:8 row_mask:0xf bank_mask:0xf
    v_add_f32_dpp v89, v89, v89 row_ror:8 row_mask:0xf bank_mask:0xf
    v_mul_f32 v80, v80, v57
    v_mul_f32 v88, v88, v73
    v_mul_f32 v81, v81, v57
    v_mul_f32 v89, v89, v73
    v_add_f32 v40, v80, v81
    v_add_f32 v41, v88, v89
    v_cvt_pk_bf16_f32 v80, v80, v81
    v_cvt_pk_bf16_f32 v88, v88, v89
    v_cmp_u_f32 vcc, v40, v41
    s_nop 0
    s_cbranch_vccnz L_dc2
    s_mov_b64 exec, s[0:1]
    s_cmp_eq_u32 s4, 0
    s_cbranch_scc1 Lg_49
    buffer_store_dword v80, v32, s[16:19], s73 offen
    buffer_store_dword v88, v32, s[16:19], s2 offen
Lb_50:
    s_mov_b64 exec, -1
    s_setpc_b64 s[30:31]
L_dc1:
    s_sub_u32 s66, s66, 1
    s_cbranch_scc1 L_end
    s_add_u32 s67, s64, 16384
    buffer_load_dwordx2 v[56:57], v12, s[16:19], s64 offen sc1
    buffer_load_dwordx2 v[58:59], v12, s[16:19], s64 offen offset:512 sc1
    buffer_load_dwordx4 v[48:51], v11, s[16:19], s64 offen sc1
    buffer_load_dwordx4 v[52:55], v11, s[16:19], s67 offen sc1
    s_waitcnt vmcnt(0)
    v_max3_u32 v40, v56, v58, v48
    v_max3_u32 v42, v50, v52, v54
    v_max_u32 v40, v40, v42
    v_cmp_eq_u32 vcc, -1, v40
    s_nop 0
    s_cbranch_vccnz L_dc1
    v_max_f32 v60, v56, v58
    s_nop 1
    v_max_f32_dpp v60, v60, v60 row_ror:4 row_mask:0xf bank_mask:0xf
    s_nop 1
    v_max_f32_dpp v60, v60, v60 row_ror:8 row_mask:0xf bank_mask:0xf
    v_mov_b32 v61, v60
    s_nop 1
    v_permlane16_swap_b32 v60, v61
    v_max_f32 v60, v60, v61
    v_mov_b32 v61, v60
    s_nop 1
    v_permlane32_swap_b32 v60, v61
    v_max_f32 v60, v60, v61
    v_sub_f32 v56, v56, v60
    v_sub_f32 v58, v58, v60
    v_cvt_i32_f32 v56, v56
    v_cvt_i32_f32 v58, v58
    v_ldexp_f32 v56, 1.0, v56
    v_ldexp_f32 v58, 1.0, v58
    v_lshrrev_b32 v62, 16, v56
    v_lshrrev_b32 v63, 16, v58
    v_mul_f32 v57, v57, v56
    v_and_b32 v56, s39, v56
    v_fmac_f32 v57, v59, v58
    v_and_b32 v58, s39, v58
    v_dot2_f32_bf16 v80, v62, v48, 0
    v_dot2_f32_bf16 v81, v56, v48, 0
    v_add_f32_dpp v57, v57, v57 row_ror:1 row_mask:0xf bank_mask:0xf
    v_dot2_f32_bf16 v82, v62, v49, 0
    v_dot2_f32_bf16 v83, v56, v49, 0
    v_add_f32_dpp v57, v57, v57 row_ror:2 row_mask:0xf bank_mask:0xf
    v_dot2_f32_bf16 v84, v62, v50, 0
    v_dot2_f32_bf16 v85, v56, v50, 0
    v_add_f32_dpp v57, v57, v57 row_ror:4 row_mask:0xf bank_mask:0xf
    v_dot2_f32_bf16 v86, v62, v51, 0
    v_dot2_f32_bf16 v87, v56, v51, 0
    v_add_f32_dpp v57, v57, v57 row_ror:8 row_mask:0xf bank_mask:0xf
    v_dot2_f32_bf16 v80, v63, v52, v80
    v_dot2_f32_bf16 v81, v58, v52, v81
    v_mov_b32 v61, v57
    v_dot2_f32_bf16 v82, v63, v53, v82
    v_dot2_f32_bf16 v83, v58, v53, v83
    v_permlane16_swap_b32 v57, v61
    v_dot2_f32_bf16 v84, v63, v54, v84
    v_dot2_f32_bf16 v85, v58, v54, v85
    v_add_f32 v57, v57, v61
    v_dot2_f32_bf16 v86, v63, v55, v86
    v_dot2_f32_bf16 v87, v58, v55, v87
    v_mov_b32 v61, v57
    v_permlane16_swap_b32 v80, v82
    v_permlane16_swap_b32 v81, v83
    v_permlane32_swap_b32 v57, v61
    v_permlane16_swap_b32 v84, v86
    v_permlane16_swap_b32 v85, v87
    v_add_f32 v57, v57, v61
    v_pk_add_f32 v[80:81], v[80:81], v[82:83]
    v_pk_add_f32 v[84:85], v[84:85], v[86:87]
    v_rcp_f32 v57, v57
    s_nop 0
    v_permlane32_swap_b32 v80, v84
    v_permlane32_swap_b32 v81, v85
    v_pk_add_f32 v[80:81], v[80:81], v[84:85]
    s_nop 1
    v_add_f32_dpp v80, v80, v80 row_ror:4 row_mask:0xf bank_mask:0xf
    v_add_f32_dpp v81, v81, v81 row_ror:4 row_mask:0xf bank_mask:0xf
    s_nop 0
    v_add_f32_dpp v80, v80, v80 row_ror:8 row_mask:0xf bank_mask:0xf
    v_add_f32_dpp v81, v81, v81 row_ror:8 row_mask:0xf bank_mask:0xf
    v_mul_f32 v80, v80, v57
    v_mul_f32 v81, v81, v57
    v_add_f32 v40, v80, v81
    v_cvt_pk_bf16_f32 v80, v80, v81
    v_cmp_u_f32 vcc, v40, v40
    s_nop 0
    s_cbranch_vccnz L_dc1
    s_mov_b64 exec, s[0:1]
    s_cmp_eq_u32 s4, 0
    s_cbranch_scc1 Lg_51
    buffer_store_dword v80, v32, s[16:19], s73 offen
Lb_52:
    s_mov_b64 exec, -1
    s_setpc_b64 s[30:31]
L_seg1s:
    s_call_b64 s[30:31], L_dc1
    s_branch L_seg1f
L_xattp:
    s_cmp_ge_u32 s3, 0xff
    s_cbranch_scc1 L_ret
    s_and_b32 s65, s3, 15
    s_lshl_b32 s65, s65, 10
    s_lshr_b32 s64, s3, 4
    s_mul_i32 s64, s64, 36864
    s_add_u32 s64, s64, 44160
    s_and_b32 s70, s3, 7
    s_lshl_b32 s70, s70, 14
    v_add_u32 v40, s70, v33
    v_xor_b32 v41, 64, v40
    v_xor_b32 v42, 128, v40
    v_xor_b32 v43, 192, v40
    ds_read_b128 v[48:51], v40 offset:0
    ds_read_b128 v[52:55], v41 offset:0
    ds_read_b128 v[56:59], v42 offset:0
    ds_read_b128 v[60:63], v43 offset:0
    ds_read_b128 v[64:67], v40 offset:4096
    ds_read_b128 v[68:71], v41 offset:4096
    ds_read_b128 v[72:75], v42 offset:4096
    ds_read_b128 v[76:79], v43 offset:4096
    s_lshl_b32 s69, s24, 6
    v_xor_b32 v44, s69, v5
    v_add_u32 v44, s70, v44
    v_mov_b32 v0, v44
    ds_read_b64_tr_b16 v[80:81], v0 offset:8192
    ds_read_b64_tr_b16 v[82:83], v0 offset:12288
    v_xor_b32 v45, 32, v0
    ds_read_b64_tr_b16 v[84:85], v45 offset:8192
    ds_read_b64_tr_b16 v[86:87], v45 offset:12288
    v_xor_b32 v45, 64, v0
    ds_read_b64_tr_b16 v[88:89], v45 offset:8192
    ds_read_b64_tr_b16 v[90:91], v45 offset:12288
    v_xor_b32 v45, 96, v0
    ds_read_b64_tr_b16 v[92:93], v45 offset:8192
    ds_read_b64_tr_b16 v[94:95], v45 offset:12288
    s_branch L_xattc
L_xattq:
    s_sub_u32 s66, s66, 1
    s_cbranch_scc1 L_end
    buffer_load_dwordx4 v[16:19], v13, s[16:19], s65 offen offset:0 sc1
    buffer_load_dwordx4 v[20:23], v13, s[16:19], s65 offen offset:64 sc1
    buffer_load_dwordx4 v[24:27], v13, s[16:19], s65 offen offset:128 sc1
    buffer_load_dwordx4 v[28:31], v13, s[16:19], s65 offen offset:192 sc1
    s_branch L_xattw
L_xatt:
    s_cmp_ge_u32 s3, 0xff
    s_cbranch_scc1 L_ret
    s_and_b32 s65, s3, 15
    s_lshl_b32 s65, s65, 10
    s_lshr_b32 s64, s3, 4
    s_mul_i32 s64, s64, 36864
    s_add_u32 s64, s64, 44160
    s_and_b32 s70, s3, 7
    s_lshl_b32 s70, s70, 14
    buffer_load_dwordx4 v[16:19], v13, s[16:19], s65 offen offset:0 sc1
    buffer_load_dwordx4 v[20:23], v13, s[16:19], s65 offen offset:64 sc1
    buffer_load_dwordx4 v[24:27], v13, s[16:19], s65 offen offset:128 sc1
    buffer_load_dwordx4 v[28:31], v13, s[16:19], s65 offen offset:192 sc1
    v_add_u32 v40, s70, v33
    v_xor_b32 v41, 64, v40
    v_xor_b32 v42, 128, v40
    v_xor_b32 v43, 192, v40
    ds_read_b128 v[48:51], v40 offset:0
    ds_read_b128 v[52:55], v41 offset:0
    ds_read_b128 v[56:59], v42 offset:0
    ds_read_b128 v[60:63], v43 offset:0
    ds_read_b128 v[64:67], v40 offset:4096
    ds_read_b128 v[68:71], v41 offset:4096
    ds_read_b128 v[72:75], v42 offset:4096
    ds_read_b128 v[76:79], v43 offset:4096
    s_lshl_b32 s69, s24, 6
    v_xor_b32 v44, s69, v5
    v_add_u32 v44, s70, v44
    v_mov_b32 v0, v44
    ds_read_b64_tr_b16 v[80:81], v0 offset:8192
    ds_read_b64_tr_b16 v[82:83], v0 offset:12288
    v_xor_b32 v45, 32, v0
    ds_read_b64_tr_b16 v[84:85], v45 offset:8192
    ds_read_b64_tr_b16 v[86:87], v45 offset:12288
    v_xor_b32 v45, 64, v0
    ds_read_b64_tr_b16 v[88:89], v45 offset:8192
    ds_read_b64_tr_b16 v[90:91], v45 offset:12288
    v_xor_b32 v45, 96, v0
    ds_read_b64_tr_b16 v[92:93], v45 offset:8192
    ds_read_b64_tr_b16 v[94:95], v45 offset:12288
L_xattw:
    s_waitcnt vmcnt(0)
L_xattc:
    s_waitcnt lgkmcnt(0)
    v_max3_u32 v40, v16, v17, v18
    v_max3_u32 v41, v19, v20, v21
    v_max3_u32 v40, v40, v22, v23
    v_max3_u32 v41, v41, v24, v25
    v_max3_u32 v40, v40, v26, v27
    v_max3_u32 v41, v41, v28, v29
    v_max3_u32 v40, v40, v30, v31
    v_max_u32 v40, v40, v41
    v_cmp_eq_u32 vcc, -1, v40
    s_nop 0
    s_cbranch_vccnz L_xattq
    v_mfma_f32_16x16x32_bf16 v[104:107], v[48:51], v[16:19], 0
    v_mfma_f32_16x16x32_bf16 v[108:111], v[64:67], v[16:19], 0
    v_mfma_f32_16x16x32_bf16 v[104:107], v[52:55], v[20:23], v[104:107]
    v_mfma_f32_16x16x32_bf16 v[108:111], v[68:71], v[20:23], v[108:111]
    v_mfma_f32_16x16x32_bf16 v[104:107], v[56:59], v[24:27], v[104:107]
    v_mfma_f32_16x16x32_bf16 v[108:111], v[72:75], v[24:27], v[108:111]
    v_mfma_f32_16x16x32_bf16 v[104:107], v[60:63], v[28:31], v[104:107]
    v_mfma_f32_16x16x32_bf16 v[108:111], v[76:79], v[28:31], v[108:111]
    v_xor_b32 v45, 128, v0
    ds_read_b64_tr_b16 v[20:21], v45 offset:8192
    ds_read_b64_tr_b16 v[22:23], v45 offset:12288
    v_xor_b32 v45, 160, v0
    ds_read_b64_tr_b16 v[24:25], v45 offset:8192
    ds_read_b64_tr_b16 v[26:27], v45 offset:12288
    v_xor_b32 v45, 192, v0
    ds_read_b64_tr_b16 v[28:29], v45 offset:8192
    ds_read_b64_tr_b16 v[30:31], v45 offset:12288
    v_subrev_u32 v46, s69, v14
    s_lshl_b32 s69, s24, 3
    v_subrev_u32 v47, s69, v15
    v_lshl_add_u32 v47, v6, 3, v47
    v_max3_f32 v16, v104, v105, v106
    v_max3_f32 v17, v107, v108, v109
    v_max3_f32 v16, v16, v110, v111
    v_max_f32 v16, v16, v17
    v_mov_b32 v17, v16
    s_nop 1
    v_permlane16_swap_b32 v16, v17
    v_max_f32 v16, v16, v17
    v_mov_b32 v17, v16
    s_nop 1
    v_permlane32_swap_b32 v16, v17
    v_max_f32 v16, v16, v17
    v_mul_f32 v44, s29, v16
    v_fma_f32 v104, v104, s29, -v44
    v_fma_f32 v105, v105, s29, -v44
    v_fma_f32 v106, v106, s29, -v44
    v_fma_f32 v107, v107, s29, -v44
    v_fma_f32 v108, v108, s29, -v44
    v_fma_f32 v109, v109, s29, -v44
    v_fma_f32 v110, v110, s29, -v44
    v_fma_f32 v111, v111, s29, -v44
    v_exp_f32 v104, v104
    v_exp_f32 v105, v105
    v_exp_f32 v106, v106
    v_exp_f32 v107, v107
    v_exp_f32 v108, v108
    v_exp_f32 v109, v109
    v_exp_f32 v110, v110
    v_exp_f32 v111, v111
    v_cvt_pk_bf16_f32 v40, v104, v105
    v_cvt_pk_bf16_f32 v41, v106, v107
    v_cvt_pk_bf16_f32 v42, v108, v109
    v_cvt_pk_bf16_f32 v43, v110, v111
    s_nop 1
    v_mfma_f32_16x16x32_bf16 v[48:51], v[80:83], v[40:43], 0
    v_xor_b32 v45, 224, v0
    ds_read_b64_tr_b16 v[80:81], v45 offset:8192
    ds_read_b64_tr_b16 v[82:83], v45 offset:12288
    v_add_f32 v17, v104, v105
    v_add_f32 v17, v17, v106
    v_mfma_f32_16x16x32_bf16 v[52:55], v[84:87], v[40:43], 0
    v_add_f32 v17, v17, v107
    v_add_f32 v17, v17, v108
    v_mfma_f32_16x16x32_bf16 v[56:59], v[88:91], v[40:43], 0
    v_add_f32 v17, v17, v109
    v_add_f32 v17, v17, v110
    v_mfma_f32_16x16x32_bf16 v[60:63], v[92:95], v[40:43], 0
    v_add_f32 v17, v17, v111
    v_mov_b32 v18, v17
    s_waitcnt lgkmcnt(2)
    v_mfma_f32_16x16x32_bf16 v[64:67], v[20:23], v[40:43], 0
    v_permlane16_swap_b32 v17, v18
    v_add_f32 v17, v17, v18
    v_mfma_f32_16x16x32_bf16 v[68:71], v[24:27], v[40:43], 0
    v_mov_b32 v18, v17
    s_nop 1
    v_permlane32_swap_b32 v17, v18
    v_mfma_f32_16x16x32_bf16 v[72:75], v[28:31], v[40:43], 0
    v_add_f32 v17, v17, v18
    v_ceil_f32 v16, v44
    s_waitcnt lgkmcnt(0)
    v_mfma_f32_16x16x32_bf16 v[76:79], v[80:83], v[40:43], 0
    v_sub_f32 v44, v44, v16
    v_exp_f32 v44, v44
    v_mul_f32 v17, 0.25, v17
    v_mul_f32 v17, v17, v44
    v_mov_b32_dpp v48, v52 quad_perm:[0,1,2,3] row_mask:0xf bank_mask:0x2
    v_mov_b32_dpp v49, v53 quad_perm:[0,1,2,3] row_mask:0xf bank_mask:0x2
    v_mov_b32_dpp v50, v54 quad_perm:[0,1,2,3] row_mask:0xf bank_mask:0x2
    v_mov_b32_dpp v51, v55 quad_perm:[0,1,2,3] row_mask:0xf bank_mask:0x2
    v_mul_f32 v48, v48, v44
    v_mul_f32 v49, v49, v44
    v_mul_f32 v50, v50, v44
    v_mul_f32 v51, v51, v44
    v_cvt_pk_bf16_f32 v48, v48, v49
    v_cvt_pk_bf16_f32 v49, v50, v51
    v_mov_b32_dpp v56, v60 quad_perm:[0,1,2,3] row_mask:0xf bank_mask:0x2
    v_mov_b32_dpp v57, v61 quad_perm:[0,1,2,3] row_mask:0xf bank_mask:0x2
    v_mov_b32_dpp v58, v62 quad_perm:[0,1,2,3] row_mask:0xf bank_mask:0x2
    v_mov_b32_dpp v59, v63 quad_perm:[0,1,2,3] row_mask:0xf bank_mask:0x2
    v_mul_f32 v56, v56, v44
    v_mul_f32 v57, v57, v44
    v_mul_f32 v58, v58, v44
    v_mul_f32 v59, v59, v44
    v_cvt_pk_bf16_f32 v56, v56, v57
    v_cvt_pk_bf16_f32 v57, v58, v59
    v_mov_b32_dpp v64, v68 quad_perm:[0,1,2,3] row_mask:0xf bank_mask:0x2
    v_mov_b32_dpp v65, v69 quad_perm:[0,1,2,3] row_mask:0xf bank_mask:0x2
    v_mov_b32_dpp v66, v70 quad_perm:[0,1,2,3] row_mask:0xf bank_mask:0x2
    v_mov_b32_dpp v67, v71 quad_perm:[0,1,2,3] row_mask:0xf bank_mask:0x2
    v_mul_f32 v64, v64, v44
    v_mul_f32 v65, v65, v44
    v_mul_f32 v66, v66, v44
    v_mul_f32 v67, v67, v44
    v_cvt_pk_bf16_f32 v64, v64, v65
    v_cvt_pk_bf16_f32 v65, v66, v67
    v_mov_b32_dpp v72, v76 quad_perm:[0,1,2,3] row_mask:0xf bank_mask:0x2
    v_mov_b32_dpp v73, v77 quad_perm:[0,1,2,3] row_mask:0xf bank_mask:0x2
    v_mov_b32_dpp v74, v78 quad_perm:[0,1,2,3] row_mask:0xf bank_mask:0x2
    v_mov_b32_dpp v75, v79 quad_perm:[0,1,2,3] row_mask:0xf bank_mask:0x2
    v_mul_f32 v72, v72, v44
    v_mul_f32 v73, v73, v44
    v_mul_f32 v74, v74, v44
    v_mul_f32 v75, v75, v44
    v_cvt_pk_bf16_f32 v72, v72, v73
    v_cvt_pk_bf16_f32 v73, v74, v75
    s_mov_b64 exec, s[56:57]
    s_cmp_eq_u32 s4, 0
    s_cbranch_scc1 Lg_53
    buffer_store_dwordx2 v[48:49], v46, s[16:19], s64 offen offset:0
    buffer_store_dwordx2 v[56:57], v46, s[16:19], s64 offen offset:64
    buffer_store_dwordx2 v[64:65], v46, s[16:19], s64 offen offset:128
    buffer_store_dwordx2 v[72:73], v46, s[16:19], s64 offen offset:192
Lb_54:
    s_mov_b64 exec, -1
    s_mov_b64 exec, 0xffff
    s_cmp_eq_u32 s4, 0
    s_cbranch_scc1 Lg_55
    buffer_store_dwordx2 v[16:17], v47, s[16:19], s64 offen
Lb_56:
    s_mov_b64 exec, -1
    s_setpc_b64 s[30:31]
Lg_5:
    s_nop 7
    buffer_store_dwordx2 v[20:21], v15, s[16:19], s64 offen sc1
    s_nop 7
    s_branch Lb_6
Lg_7:
    s_nop 7
    buffer_store_dwordx2 v[48:49], v14, s[16:19], s64 offen sc1
    s_nop 7
    s_branch Lb_8
Lg_9:
    s_nop 7
    buffer_store_dwordx2 v[20:21], v15, s[16:19], s64 offen sc1
    s_nop 7
    s_branch Lb_10
Lg_11:
    s_nop 7
    buffer_store_dwordx2 v[48:49], v14, s[16:19], s64 offen sc1
    s_nop 7
    s_branch Lb_12
Lg_13:
    s_nop 7
    buffer_store_dwordx2 v[20:21], v15, s[16:19], s64 offen sc1
    s_nop 7
    s_branch Lb_14
Lg_15:
    s_nop 7
    buffer_store_dwordx2 v[48:49], v14, s[16:19], s64 offen sc1
    s_nop 7
    s_branch Lb_16
Lg_17:
    s_nop 7
    buffer_store_dwordx2 v[48:49], v14, s[16:19], s64 offen sc1
    s_nop 7
    s_branch Lb_18
Lg_19:
    s_nop 7
    buffer_store_dwordx2 v[196:197], v15, s[16:19], s64 offen sc1
    buffer_store_dwordx2 v[198:199], v15, s[16:19], s70 offen sc1
    s_nop 7
    s_branch Lb_20
Lg_21:
    s_nop 7
    buffer_store_dwordx2 v[240:241], v14, s[16:19], s70 offen sc1
    s_nop 7
    s_branch Lb_22
Lg_25:
    s_nop 7
    buffer_store_dword v112, v252, s[16:19], s67 offen sc1
    buffer_store_dword v113, v252, s[16:19], s68 offen sc1
    buffer_store_dword v114, v252, s[16:19], s69 offen sc1
    buffer_store_dword v115, v252, s[16:19], s70 offen sc1
    s_nop 7
    s_branch Lb_26
Lg_27:
    s_nop 7
    buffer_store_dwordx4 v[40:43], v123, s[16:19], s67 offen offset:0 sc1
    buffer_store_dwordx4 v[40:43], v123, s[16:19], s67 offen offset:1024 sc1
    buffer_store_dwordx4 v[40:43], v123, s[16:19], s67 offen offset:1280 sc1
    s_nop 7
    s_branch Lb_28
Lg_29:
    s_nop 7
    buffer_store_dwordx4 v[40:43], v123, s[16:19], s67 offen offset:0 sc1
    buffer_store_dwordx4 v[40:43], v123, s[16:19], s67 offen offset:1024 sc1
    buffer_store_dwordx4 v[40:43], v123, s[16:19], s67 offen offset:1280 sc1
    s_nop 7
    s_branch Lb_30
Lg_31:
    s_nop 7
    buffer_store_dwordx4 v[40:43], v123, s[16:19], s67 offen offset:0 sc1
    buffer_store_dwordx4 v[40:43], v123, s[16:19], s67 offen offset:1024 sc1
    buffer_store_dwordx4 v[40:43], v123, s[16:19], s67 offen offset:1280 sc1
    s_nop 7
    s_branch Lb_32
Lg_33:
    s_nop 7
    buffer_store_dwordx4 v[40:43], v123, s[16:19], s67 offen offset:0 sc1
    buffer_store_dwordx4 v[40:43], v123, s[16:19], s67 offen offset:1024 sc1
    buffer_store_dwordx4 v[40:43], v123, s[16:19], s67 offen offset:1280 sc1
    s_nop 7
    s_branch Lb_34
Lg_35:
    s_nop 7
    buffer_store_dwordx4 v[40:43], v123, s[16:19], s67 offen offset:0 sc1
    buffer_store_dwordx4 v[40:43], v123, s[16:19], s67 offen offset:1024 sc1
    buffer_store_dwordx4 v[40:43], v123, s[16:19], s67 offen offset:1280 sc1
    s_nop 7
    s_branch Lb_36
Lg_37:
    s_nop 7
    buffer_store_dwordx4 v[40:43], v123, s[16:19], s67 offen offset:0 sc1
    buffer_store_dwordx4 v[40:43], v123, s[16:19], s67 offen offset:1024 sc1
    buffer_store_dwordx4 v[40:43], v123, s[16:19], s67 offen offset:1280 sc1
    s_nop 7
    s_branch Lb_38
Lg_41:
    s_nop 7
    buffer_store_dword v104, v8, s[16:19], s41 offen sc1
    s_nop 7
    s_branch Lb_42
Lg_46:
    s_nop 7
    buffer_store_dword v104, v4, s[16:19], s54 offen sc1
    s_nop 7
    s_branch Lb_47
Lg_49:
    s_nop 7
    buffer_store_dword v80, v32, s[16:19], s73 offen sc1
    buffer_store_dword v88, v32, s[16:19], s2 offen sc1
    s_nop 7
    s_branch Lb_50
Lg_51:
    s_nop 7
    buffer_store_dword v80, v32, s[16:19], s73 offen sc1
    s_nop 7
    s_branch Lb_52
Lg_53:
    s_nop 7
    buffer_store_dwordx2 v[48:49], v46, s[16:19], s64 offen offset:0 sc1
    buffer_store_dwordx2 v[56:57], v46, s[16:19], s64 offen offset:64 sc1
    buffer_store_dwordx2 v[64:65], v46, s[16:19], s64 offen offset:128 sc1
    buffer_store_dwordx2 v[72:73], v46, s[16:19], s64 offen offset:192 sc1
    s_nop 7
    s_branch Lb_54
Lg_55:
    s_nop 7
    buffer_store_dwordx2 v[16:17], v47, s[16:19], s64 offen sc1
    s_nop 7
    s_branch Lb_56
L_end:
    s_endpgm
.fill 64, 4, 0xBF800000
    s_endpgm
.section .rodata,"a"
.p2align 6
.amdhsa_kernel interleave_layers__gqa_block_cached__dense_activation_silu__decode_kernel
  .amdhsa_next_free_vgpr 512
  .amdhsa_next_free_sgpr 102
  .amdhsa_accum_offset 256
  .amdhsa_group_segment_fixed_size 0
  .amdhsa_kernarg_size 88
  .amdhsa_user_sgpr_count 2
  .amdhsa_user_sgpr_kernarg_segment_ptr 1
  .amdhsa_system_sgpr_workgroup_id_x 1
  .amdhsa_float_denorm_mode_32 3
.end_amdhsa_kernel
```
